```python
import torch

def _softmax(x, axis=-1):
    return torch.softmax(x, dim=axis)
def _gelu(x):
    return torch.nn.functional.gelu(x, approximate="tanh")
def _silu(x):
    return torch.nn.functional.silu(x)
def _sigmoid(x):
    return torch.sigmoid(x)
def _layernorm(x, axis=-1, eps=1e-5):
    m = x.mean(dim=axis, keepdim=True)
    v = x.var(dim=axis, keepdim=True, unbiased=False)
    return (x - m) / torch.sqrt(v + eps)
def _scatter_add(tgt, idx, src, axis=0):
    return tgt.clone().index_add_(axis, idx, src)
def _segment_sum(src, seg, n):
    out = torch.zeros((n,) + src.shape[1:], dtype=src.dtype)
    return out.index_add_(0, seg, src)
def _pad(x, pw):
    flat = tuple(v for pair in reversed(pw) for v in pair)
    return torch.nn.functional.pad(x, flat)

kernel_name = 'parallel_sum__mha_block_cached__geglu_ffn__decode'

def setup_inputs():

    _w = (lambda a: (lambda t: t.to(torch.bfloat16) if t.is_floating_point() else t)(torch.as_tensor(a)))
    def _A_setup():
        B, Sq, D = 1, 1, 640
        H, Sk, Dh = 32, 32768, 192
        return {
            "x": _w((lambda *s: torch.randn(*s, dtype=torch.bfloat16) * 0.05)(B, Sq, D)),
            "k_cache": _w((lambda *s: torch.randn(*s, dtype=torch.bfloat16) * 3.2)(B, H, Sk, Dh)),
            "v_cache": _w((lambda *s: torch.randn(*s, dtype=torch.bfloat16) * 1.6)(B, H, Sk, Dh)),
            "wq": _w((lambda *s: torch.randn(*s, dtype=torch.bfloat16) * 3.2)(D, H * Dh) * (D ** -0.5)),
            "wo": _w((lambda *s: torch.randn(*s, dtype=torch.bfloat16) * 1.6)(H * Dh, D) * ((H * Dh) ** -0.5)),
        }
    _A_in = _A_setup()

    def _B_setup():
        B, S, D, F = 1, 1, 640, 1536
        return {
            "x": _w((lambda *s: torch.randn(*s, dtype=torch.bfloat16) * 0.05)(B, S, D)),
            "w_gate": _w((lambda *s: torch.randn(*s, dtype=torch.bfloat16) * 0.05)(D, F)),
            "w_up": _w((lambda *s: torch.randn(*s, dtype=torch.bfloat16) * 0.05)(D, F)),
            "w_down": _w((lambda *s: torch.randn(*s, dtype=torch.bfloat16) * 0.05)(F, D)),
        }
    _B_in = _B_setup()

    return {
        "A_x": _A_in["x"],
        "A_k_cache": _A_in["k_cache"],
        "A_v_cache": _A_in["v_cache"],
        "A_wq": _A_in["wq"],
        "A_wo": _A_in["wo"],
        "B_x": _B_in["x"],
        "B_w_gate": _B_in["w_gate"],
        "B_w_up": _B_in["w_up"],
        "B_w_down": _B_in["w_down"],
    }

def reference(A_x, A_k_cache, A_v_cache, A_wq, A_wo, B_x, B_w_gate, B_w_up, B_w_down):
    def _A_ref(x, k_cache, v_cache, wq, wo):
        B, Sq, D = x.shape
        H, Dh = 32, 192
        q = (lambda x, *d: x.permute(*d))((x @ wq).reshape(B, Sq, H, Dh), 0, 2, 1, 3)
        scores = torch.einsum("bhqd,bhkd->bhqk", q, k_cache) * (Dh ** -0.5)
        p = _softmax(scores, axis=-1)
        o = torch.einsum("bhqk,bhkd->bhqd", p, v_cache)
        return (lambda x, *d: x.permute(*d))(o, 0, 2, 1, 3).reshape(B, Sq, H * Dh) @ wo

    def _B_ref(x, w_gate, w_up, w_down):
        return (_gelu(x @ w_gate) * (x @ w_up)) @ w_down

    x = A_x
    xn = _layernorm(x, axis=-1)
    return x + _A_ref(xn, A_k_cache, A_v_cache, A_wq, A_wo) + _B_ref(xn, B_w_gate, B_w_up, B_w_down)
```

```asm
; @launch grid=(256,1,1) block=(256,1,1) lds=52736
.amdgcn_target "amdgcn-amd-amdhsa--gfx950"
.text
.globl parallel_sum__mha_block_cached__geglu_ffn__decode_kernel
.p2align 8
.type parallel_sum__mha_block_cached__geglu_ffn__decode_kernel,@function
parallel_sum__mha_block_cached__geglu_ffn__decode_kernel:
    s_cmp_ge_u32 s2, 256
    s_cbranch_scc1 L_exit
    s_load_dwordx16 s[16:31], s[0:1], 0
    s_load_dwordx8 s[32:39], s[0:1], 64
    v_lshrrev_b32 v1, 6, v0
    v_and_b32 v0, 63, v0
    v_readfirstlane_b32 s3, v1
    s_and_b32 s4, s2, 7
    s_lshr_b32 s5, s2, 3
    v_lshrrev_b32 v1, 3, v0
    v_and_b32 v2, 7, v0
    s_mul_i32 s40, s5, 43691
    s_lshr_b32 s40, s40, 17
    s_mul_i32 s41, s40, 3
    s_sub_u32 s41, s5, s41
    s_cmp_eq_u32 s3, 2
    s_cbranch_scc1 L_helperA
    s_cmp_eq_u32 s3, 3
    s_cbranch_scc1 L_helperB
    s_getpc_b64 s[12:13]
L_pc:
    s_lshl_b32 s6, s5, 1
    s_add_u32 s6, s6, s3
    s_lshl_b32 s6, s6, 10
    v_lshl_add_u32 v8, v0, 4, s6
    v_min_u32 v8, L_code_end-L_pc-16, v8
    v_mov_b32 v9, s13
    v_add_co_u32 v8, vcc, s12, v8
    s_nop 1
    v_addc_co_u32 v9, vcc, 0, v9, vcc
    global_load_dwordx4 v[64:67], v[8:9], off
    v_mul_u32_u24 v3, 384, v1
    v_lshl_add_u32 v3, v2, 4, v3
    s_mul_i32 s6, s3, 128
    s_add_u32 s6, s6, 5632
    v_mul_u32_u24 v4, 16, v1
    v_add_u32 v4, s6, v4
    v_lshlrev_b32 v5, 4, v2
    s_mul_i32 s6, s3, 6144
    s_add_u32 s6, s6, 15872
    v_mul_u32_u24 v6, 768, v1
    v_lshl_add_u32 v6, v2, 5, v6
    v_add_u32 v6, s6, v6
    s_mul_i32 s44, s4, 12582912
    s_mul_i32 s6, s5, 2
    s_add_u32 s6, s6, s3
    s_mul_i32 s6, s6, 6144
    s_add_u32 s44, s44, s6
    s_lshl_b32 s7, s3, 2
    v_mov_b32 v7, s7
    v_mov_b32 v13, 0
    s_waitcnt lgkmcnt(0)
    s_mov_b32 s8, s18
    s_mov_b32 s9, s19
    s_mov_b32 s10, 402653184
    s_mov_b32 s11, 0x20000
    s_barrier
    s_mov_b32 s48, 0
    s_mov_b32 s53, 1
    s_mov_b32 s46, 11403264
    s_mov_b32 s47, 88473600
    s_mul_i32 s6, s4, 11010048
    s_sub_u32 s42, 88473600, s6
    s_add_u32 s43, s6, 11403264
    v_and_b32 v8, 1, v1
    v_bfe_u32 v18, v0, 4, 1
    v_cmp_eq_u32 vcc, 1, v8
    v_lshrrev_b32 v9, 5, v0
    v_lshlrev_b32 v19, 4, v0
    v_cndmask_b32 v18, v18, 2, vcc
    v_lshlrev_b32 v18, 13, v18
    v_lshl_add_u32 v18, v9, 10, v18
    v_lshl_add_u32 v18, v2, 7, v18
    s_mul_i32 s57, s4, 270336
    s_lshr_b32 s7, s5, 3
    s_lshl_b32 s7, s7, 11
    s_add_u32 s57, s57, s7
    s_and_b32 s7, s5, 7
    s_lshl_b32 s7, s7, 4
    s_add_u32 s57, s57, s7
    s_add_u32 s57, s57, 1163264
    s_mov_b32 s12, s38
    s_mov_b32 s13, s39
    s_mov_b32 s14, 4194304
    s_mov_b32 s15, 0x20000
    v_lshlrev_b32 v59, 2, v0
    v_lshlrev_b32 v58, 24, v0
    s_mul_i32 s59, s4, 4352
    s_add_u32 s59, s59, 524288
    s_lshl_b32 s6, s5, 1
    s_add_u32 s6, s6, s3
    s_lshl_b32 s6, s6, 2
    s_add_u32 s58, s59, s6
    s_cmp_eq_u32 s6, 252
    s_cselect_b32 s58, 4194304, s58
    s_mov_b32 s62, 4000000
    v_mov_b32 v12, 0
L_wl_1:
    ds_read_b32 v8, v12 offset:24
    s_waitcnt lgkmcnt(0)
    s_nop 0
    v_readfirstlane_b32 s63, v8
    s_cmp_ge_u32 s63, 1
    s_cbranch_scc1 L_wlok_2
    s_sleep 1
    s_sub_u32 s62, s62, 1
    s_cmp_lg_u32 s62, 0
    s_cbranch_scc1 L_wl_1
    s_endpgm
L_wlok_2:
    v_mov_b32 v12, 0
    ds_read_b32 v8, v12 offset:32
    s_waitcnt lgkmcnt(0)
    v_readfirstlane_b32 s60, v8
    s_nop 1
    s_lshl_b32 s6, s3, 10
    v_add_u32 v24, s6, v19
    v_xor_b32 v25, 0x400, v24
    v_xor_b32 v26, 4, v7
    v_mov_b32 v27, 1
    v_mov_b32 v19, 65
    s_add_u32 s55, s60, 0x1000
    s_mov_b32 s62, 4000000
    v_mov_b32 v12, 0
L_wl_3:
    ds_read_b32 v8, v12 offset:28
    s_waitcnt lgkmcnt(0)
    s_nop 0
    v_readfirstlane_b32 s63, v8
    s_cmp_ge_u32 s63, 1
    s_cbranch_scc1 L_wlok_4
    s_sleep 1
    s_sub_u32 s62, s62, 1
    s_cmp_lg_u32 s62, 0
    s_cbranch_scc1 L_wl_3
    s_endpgm
L_wlok_4:
    s_waitcnt vmcnt(0)
    buffer_load_dwordx4 v[64:67], v3, s[8:11], s44 offen offset:0 nt
    buffer_load_dwordx4 v[68:71], v3, s[8:11], s44 offen offset:128 nt
    buffer_load_dwordx4 v[72:75], v3, s[8:11], s44 offen offset:256 nt
    buffer_load_dwordx4 v[76:79], v3, s[8:11], s44 offen offset:3072 nt
    buffer_load_dwordx4 v[80:83], v3, s[8:11], s44 offen offset:3200 nt
    buffer_load_dwordx4 v[84:87], v3, s[8:11], s44 offen offset:3328 nt
    s_add_u32 s44, s44, 393216
    buffer_load_dwordx4 v[88:91], v3, s[8:11], s44 offen offset:0 nt
    buffer_load_dwordx4 v[92:95], v3, s[8:11], s44 offen offset:128 nt
    buffer_load_dwordx4 v[96:99], v3, s[8:11], s44 offen offset:256 nt
    buffer_load_dwordx4 v[100:103], v3, s[8:11], s44 offen offset:3072 nt
    buffer_load_dwordx4 v[104:107], v3, s[8:11], s44 offen offset:3200 nt
    s_waitcnt vmcnt(10)
    buffer_load_dwordx4 v[108:111], v3, s[8:11], s44 offen offset:3328 nt
    s_add_u32 s44, s44, 393216
    s_waitcnt vmcnt(10)
    buffer_load_dwordx4 v[112:115], v3, s[8:11], s44 offen offset:0 nt
    s_waitcnt vmcnt(10)
    buffer_load_dwordx4 v[116:119], v3, s[8:11], s44 offen offset:128 nt
    s_waitcnt vmcnt(10)
    buffer_load_dwordx4 v[120:123], v3, s[8:11], s44 offen offset:256 nt
    s_waitcnt vmcnt(10)
    buffer_load_dwordx4 v[124:127], v3, s[8:11], s44 offen offset:3072 nt
    s_waitcnt vmcnt(10)
    buffer_load_dwordx4 v[128:131], v3, s[8:11], s44 offen offset:3200 nt
    s_waitcnt vmcnt(10)
    buffer_load_dwordx4 v[132:135], v3, s[8:11], s44 offen offset:3328 nt
    s_add_u32 s44, s44, 393216
    s_waitcnt vmcnt(10)
    buffer_load_dwordx4 v[136:139], v3, s[8:11], s44 offen offset:0 nt
    s_waitcnt vmcnt(10)
    buffer_load_dwordx4 v[140:143], v3, s[8:11], s44 offen offset:128 nt
    s_waitcnt vmcnt(10)
    buffer_load_dwordx4 v[144:147], v3, s[8:11], s44 offen offset:256 nt
    s_mov_b32 s62, 4000000
    v_mov_b32 v12, 0
L_wl_5:
    ds_read_b32 v8, v12 offset:16
    s_waitcnt lgkmcnt(0)
    s_nop 0
    v_readfirstlane_b32 s63, v8
    s_cmp_ge_u32 s63, 1
    s_cbranch_scc1 L_wlok_6
    s_sub_u32 s62, s62, 1
    s_cmp_lg_u32 s62, 0
    s_cbranch_scc1 L_wl_5
    s_endpgm
L_wlok_6:
    ds_read_b128 v[28:31], v5 offset:64
    ds_read_b128 v[32:35], v5 offset:192
    ds_read_b128 v[36:39], v5 offset:320
    v_add_u32 v5, 384, v5
L_kloop:
    s_cmp_eq_u32 s53, 1
    s_cbranch_scc1 L_kb1
    s_cmp_eq_u32 s53, 2
    s_cbranch_scc1 L_kb2
L_kb0:
    s_waitcnt vmcnt(6)
    buffer_load_dwordx4 v[148:151], v3, s[8:11], s44 offen offset:3072 nt
    buffer_load_dwordx4 v[152:155], v3, s[8:11], s44 offen offset:3200 nt
    buffer_load_dwordx4 v[156:159], v3, s[8:11], s44 offen offset:3328 nt
    s_bitcmp1_b32 0x7f0000, s48
    s_cselect_b32 s45, s46, 393216
    s_cmp_eq_u32 s48, 7
    s_cselect_b32 s45, s47, s45
    s_cmp_eq_u32 s48, 15
    s_cselect_b32 s45, s42, s45
    s_cmp_eq_u32 s48, 23
    s_cselect_b32 s45, s43, s45
    s_cmp_eq_u32 s48, 31
    s_cselect_b32 s45, 0xed460000, s45
    s_cselect_b32 s8, s20, s8
    s_cselect_b32 s9, s21, s9
    s_add_u32 s44, s44, s45
    v_add_u32 v57, s60, v13
    buffer_store_dword v57, v58, s[12:15], s58 offen
    buffer_load_dword v56, v59, s[12:15], s59 offen sc1
    s_waitcnt lgkmcnt(0)
    v_mov_b32 v14, 0
    v_dot2c_f32_bf16 v14, v64, v28
    v_dot2c_f32_bf16 v14, v65, v29
    v_dot2c_f32_bf16 v14, v66, v30
    v_dot2c_f32_bf16 v14, v67, v31
    v_dot2c_f32_bf16 v14, v68, v32
    v_dot2c_f32_bf16 v14, v69, v33
    v_dot2c_f32_bf16 v14, v70, v34
    v_dot2c_f32_bf16 v14, v71, v35
    v_dot2c_f32_bf16 v14, v72, v36
    v_dot2c_f32_bf16 v14, v73, v37
    v_dot2c_f32_bf16 v14, v74, v38
    v_dot2c_f32_bf16 v14, v75, v39
    s_waitcnt vmcnt(8)
    buffer_load_dwordx4 v[64:67], v3, s[8:11], s44 offen offset:0 nt
    buffer_load_dwordx4 v[68:71], v3, s[8:11], s44 offen offset:128 nt
    buffer_load_dwordx4 v[72:75], v3, s[8:11], s44 offen offset:256 nt
    v_mov_b32 v15, 0
    v_add_f32_dpp v14, v14, v14 quad_perm:[1,0,3,2] row_mask:0xf bank_mask:0xf
    v_dot2c_f32_bf16 v15, v76, v28
    v_dot2c_f32_bf16 v15, v77, v29
    v_add_f32_dpp v14, v14, v14 quad_perm:[2,3,0,1] row_mask:0xf bank_mask:0xf
    v_dot2c_f32_bf16 v15, v78, v30
    v_dot2c_f32_bf16 v15, v79, v31
    v_add_f32_dpp v14, v14, v14 row_half_mirror row_mask:0xf bank_mask:0xf
    v_dot2c_f32_bf16 v15, v80, v32
    v_dot2c_f32_bf16 v15, v81, v33
    v_dot2c_f32_bf16 v15, v82, v34
    v_dot2c_f32_bf16 v15, v83, v35
    v_dot2c_f32_bf16 v15, v84, v36
    v_dot2c_f32_bf16 v15, v85, v37
    v_dot2c_f32_bf16 v15, v86, v38
    v_dot2c_f32_bf16 v15, v87, v39
    s_waitcnt vmcnt(8)
    buffer_load_dwordx4 v[76:79], v3, s[8:11], s44 offen offset:3072 nt
    buffer_load_dwordx4 v[80:83], v3, s[8:11], s44 offen offset:3200 nt
    buffer_load_dwordx4 v[84:87], v3, s[8:11], s44 offen offset:3328 nt
    s_add_u32 s44, s44, 393216
    v_mov_b32 v16, 0
    v_add_f32_dpp v15, v15, v15 quad_perm:[1,0,3,2] row_mask:0xf bank_mask:0xf
    v_dot2c_f32_bf16 v16, v88, v28
    v_dot2c_f32_bf16 v16, v89, v29
    v_add_f32_dpp v15, v15, v15 quad_perm:[2,3,0,1] row_mask:0xf bank_mask:0xf
    v_dot2c_f32_bf16 v16, v90, v30
    v_dot2c_f32_bf16 v16, v91, v31
    v_add_f32_dpp v15, v15, v15 row_half_mirror row_mask:0xf bank_mask:0xf
    v_dot2c_f32_bf16 v16, v92, v32
    v_cvt_pk_bf16_f32 v20, v14, v15
    v_dot2c_f32_bf16 v16, v93, v33
    v_dot2c_f32_bf16 v16, v94, v34
    v_dot2c_f32_bf16 v16, v95, v35
    v_dot2c_f32_bf16 v16, v96, v36
    v_dot2c_f32_bf16 v16, v97, v37
    v_dot2c_f32_bf16 v16, v98, v38
    v_dot2c_f32_bf16 v16, v99, v39
    s_waitcnt vmcnt(8)
    buffer_load_dwordx4 v[88:91], v3, s[8:11], s44 offen offset:0 nt
    buffer_load_dwordx4 v[92:95], v3, s[8:11], s44 offen offset:128 nt
    buffer_load_dwordx4 v[96:99], v3, s[8:11], s44 offen offset:256 nt
    v_mov_b32 v17, 0
    v_add_f32_dpp v16, v16, v16 quad_perm:[1,0,3,2] row_mask:0xf bank_mask:0xf
    v_dot2c_f32_bf16 v17, v100, v28
    v_dot2c_f32_bf16 v17, v101, v29
    v_add_f32_dpp v16, v16, v16 quad_perm:[2,3,0,1] row_mask:0xf bank_mask:0xf
    v_dot2c_f32_bf16 v17, v102, v30
    v_dot2c_f32_bf16 v17, v103, v31
    v_add_f32_dpp v16, v16, v16 row_half_mirror row_mask:0xf bank_mask:0xf
    v_dot2c_f32_bf16 v17, v104, v32
    v_dot2c_f32_bf16 v17, v105, v33
    v_dot2c_f32_bf16 v17, v106, v34
    v_dot2c_f32_bf16 v17, v107, v35
    v_dot2c_f32_bf16 v17, v108, v36
    v_dot2c_f32_bf16 v17, v109, v37
    v_dot2c_f32_bf16 v17, v110, v38
    v_dot2c_f32_bf16 v17, v111, v39
    s_waitcnt vmcnt(6)
    buffer_load_dwordx4 v[100:103], v3, s[8:11], s44 offen offset:3072 nt
    buffer_load_dwordx4 v[104:107], v3, s[8:11], s44 offen offset:3200 nt
    buffer_load_dwordx4 v[108:111], v3, s[8:11], s44 offen offset:3328 nt
    s_add_u32 s44, s44, 393216
    v_mov_b32 v14, 0
    v_add_f32_dpp v17, v17, v17 quad_perm:[1,0,3,2] row_mask:0xf bank_mask:0xf
    v_dot2c_f32_bf16 v14, v112, v28
    v_dot2c_f32_bf16 v14, v113, v29
    v_add_f32_dpp v17, v17, v17 quad_perm:[2,3,0,1] row_mask:0xf bank_mask:0xf
    v_dot2c_f32_bf16 v14, v114, v30
    v_dot2c_f32_bf16 v14, v115, v31
    v_add_f32_dpp v17, v17, v17 row_half_mirror row_mask:0xf bank_mask:0xf
    v_dot2c_f32_bf16 v14, v116, v32
    v_cvt_pk_bf16_f32 v21, v16, v17
    v_dot2c_f32_bf16 v14, v117, v33
    v_dot2c_f32_bf16 v14, v118, v34
    v_dot2c_f32_bf16 v14, v119, v35
    v_dot2c_f32_bf16 v14, v120, v36
    v_dot2c_f32_bf16 v14, v121, v37
    v_dot2c_f32_bf16 v14, v122, v38
    v_dot2c_f32_bf16 v14, v123, v39
    s_waitcnt vmcnt(6)
    buffer_load_dwordx4 v[112:115], v3, s[8:11], s44 offen offset:0 nt
    buffer_load_dwordx4 v[116:119], v3, s[8:11], s44 offen offset:128 nt
    buffer_load_dwordx4 v[120:123], v3, s[8:11], s44 offen offset:256 nt
    v_mov_b32 v15, 0
    v_add_f32_dpp v14, v14, v14 quad_perm:[1,0,3,2] row_mask:0xf bank_mask:0xf
    v_dot2c_f32_bf16 v15, v124, v28
    v_dot2c_f32_bf16 v15, v125, v29
    v_add_f32_dpp v14, v14, v14 quad_perm:[2,3,0,1] row_mask:0xf bank_mask:0xf
    v_dot2c_f32_bf16 v15, v126, v30
    v_dot2c_f32_bf16 v15, v127, v31
    v_add_f32_dpp v14, v14, v14 row_half_mirror row_mask:0xf bank_mask:0xf
    v_dot2c_f32_bf16 v15, v128, v32
    v_dot2c_f32_bf16 v15, v129, v33
    v_dot2c_f32_bf16 v15, v130, v34
    v_dot2c_f32_bf16 v15, v131, v35
    s_waitcnt vmcnt(15)
    v_readlane_b32 s93, v56, 63
    v_dot2c_f32_bf16 v15, v132, v36
    v_dot2c_f32_bf16 v15, v133, v37
    v_dot2c_f32_bf16 v15, v134, v38
    v_sub_u32 v56, v56, v57
    v_dot2c_f32_bf16 v15, v135, v39
    s_waitcnt vmcnt(6)
    buffer_load_dwordx4 v[124:127], v3, s[8:11], s44 offen offset:3072 nt
    buffer_load_dwordx4 v[128:131], v3, s[8:11], s44 offen offset:3200 nt
    buffer_load_dwordx4 v[132:135], v3, s[8:11], s44 offen offset:3328 nt
    s_add_u32 s44, s44, 393216
    v_add_u32 v57, 8, v56
    v_mov_b32 v16, 0
    v_add_f32_dpp v15, v15, v15 quad_perm:[1,0,3,2] row_mask:0xf bank_mask:0xf
    v_dot2c_f32_bf16 v16, v136, v28
    v_dot2c_f32_bf16 v16, v137, v29
    v_add_f32_dpp v15, v15, v15 quad_perm:[2,3,0,1] row_mask:0xf bank_mask:0xf
    v_dot2c_f32_bf16 v16, v138, v30
    v_cmp_gt_u32 vcc, 17, v57
    v_dot2c_f32_bf16 v16, v139, v31
    v_add_f32_dpp v15, v15, v15 row_half_mirror row_mask:0xf bank_mask:0xf
    s_nop 0
    v_lshl_add_u32 v56, v56, 1, 1
    v_dot2c_f32_bf16 v16, v140, v32
    v_cvt_pk_bf16_f32 v22, v14, v15
    v_dot2c_f32_bf16 v16, v141, v33
    v_dot2c_f32_bf16 v16, v142, v34
    v_cndmask_b32 v56, 0, v56, vcc
    v_dot2c_f32_bf16 v16, v143, v35
    s_nop 0
    v_add_u32_dpp v56, v56, v56 quad_perm:[1,0,3,2] row_mask:0xf bank_mask:0xf
    v_dot2c_f32_bf16 v16, v144, v36
    v_dot2c_f32_bf16 v16, v145, v37
    v_dot2c_f32_bf16 v16, v146, v38
    v_add_u32_dpp v56, v56, v56 quad_perm:[2,3,0,1] row_mask:0xf bank_mask:0xf
    v_dot2c_f32_bf16 v16, v147, v39
    s_waitcnt vmcnt(6)
    buffer_load_dwordx4 v[136:139], v3, s[8:11], s44 offen offset:0 nt
    buffer_load_dwordx4 v[140:143], v3, s[8:11], s44 offen offset:128 nt
    buffer_load_dwordx4 v[144:147], v3, s[8:11], s44 offen offset:256 nt
    v_add_u32_dpp v56, v56, v56 row_half_mirror row_mask:0xf bank_mask:0xf
    v_mov_b32 v17, 0
    v_add_f32_dpp v16, v16, v16 quad_perm:[1,0,3,2] row_mask:0xf bank_mask:0xf
    v_dot2c_f32_bf16 v17, v148, v28
    v_dot2c_f32_bf16 v17, v149, v29
    v_add_f32_dpp v16, v16, v16 quad_perm:[2,3,0,1] row_mask:0xf bank_mask:0xf
    v_dot2c_f32_bf16 v17, v150, v30
    v_add_u32_dpp v56, v56, v56 row_mirror row_mask:0xf bank_mask:0xf
    v_dot2c_f32_bf16 v17, v151, v31
    v_add_f32_dpp v16, v16, v16 row_half_mirror row_mask:0xf bank_mask:0xf
    s_nop 0
    v_readlane_b32 s88, v56, 0
    v_dot2c_f32_bf16 v17, v152, v32
    v_dot2c_f32_bf16 v17, v153, v33
    v_dot2c_f32_bf16 v17, v154, v34
    v_readlane_b32 s89, v56, 16
    v_dot2c_f32_bf16 v17, v155, v35
    s_nop 0
    v_readlane_b32 s90, v56, 32
    v_dot2c_f32_bf16 v17, v156, v36
    v_dot2c_f32_bf16 v17, v157, v37
    v_dot2c_f32_bf16 v17, v158, v38
    v_readlane_b32 s91, v56, 48
    v_dot2c_f32_bf16 v17, v159, v39
    s_nop 0
    s_nop 0
    s_nop 0
    v_add_f32_dpp v17, v17, v17 quad_perm:[1,0,3,2] row_mask:0xf bank_mask:0xf
    s_nop 0
    s_nop 0
    v_add_f32_dpp v17, v17, v17 quad_perm:[2,3,0,1] row_mask:0xf bank_mask:0xf
    s_nop 0
    s_nop 0
    v_add_f32_dpp v17, v17, v17 row_half_mirror row_mask:0xf bank_mask:0xf
    s_nop 0
    v_cvt_pk_bf16_f32 v23, v16, v17
    s_branch L_kb_end
L_kb2:
    s_waitcnt vmcnt(12)
    buffer_load_dwordx4 v[148:151], v3, s[8:11], s44 offen offset:3072 nt
    buffer_load_dwordx4 v[152:155], v3, s[8:11], s44 offen offset:3200 nt
    buffer_load_dwordx4 v[156:159], v3, s[8:11], s44 offen offset:3328 nt
    s_bitcmp1_b32 0x7f0000, s48
    s_cselect_b32 s45, s46, 393216
    s_cmp_eq_u32 s48, 7
    s_cselect_b32 s45, s47, s45
    s_cmp_eq_u32 s48, 15
    s_cselect_b32 s45, s42, s45
    s_cmp_eq_u32 s48, 23
    s_cselect_b32 s45, s43, s45
    s_cmp_eq_u32 s48, 31
    s_cselect_b32 s45, 0xed460000, s45
    s_cselect_b32 s8, s20, s8
    s_cselect_b32 s9, s21, s9
    s_add_u32 s44, s44, s45
    v_add_u32 v57, s60, v13
    buffer_store_dword v57, v58, s[12:15], s58 offen
    buffer_load_dword v56, v59, s[12:15], s59 offen sc1
    s_waitcnt lgkmcnt(0)
    v_mov_b32 v14, 0
    v_dot2c_f32_bf16 v14, v64, v28
    v_dot2c_f32_bf16 v14, v65, v29
    v_dot2c_f32_bf16 v14, v66, v30
    v_dot2c_f32_bf16 v14, v67, v31
    v_dot2c_f32_bf16 v14, v68, v32
    v_dot2c_f32_bf16 v14, v69, v33
    v_dot2c_f32_bf16 v14, v70, v34
    v_dot2c_f32_bf16 v14, v71, v35
    v_dot2c_f32_bf16 v14, v72, v36
    v_dot2c_f32_bf16 v14, v73, v37
    v_dot2c_f32_bf16 v14, v74, v38
    v_dot2c_f32_bf16 v14, v75, v39
    s_waitcnt vmcnt(14)
    buffer_load_dwordx4 v[64:67], v3, s[8:11], s44 offen offset:0 nt
    buffer_load_dwordx4 v[68:71], v3, s[8:11], s44 offen offset:128 nt
    buffer_load_dwordx4 v[72:75], v3, s[8:11], s44 offen offset:256 nt
    v_mov_b32 v15, 0
    v_add_f32_dpp v14, v14, v14 quad_perm:[1,0,3,2] row_mask:0xf bank_mask:0xf
    v_dot2c_f32_bf16 v15, v76, v28
    v_dot2c_f32_bf16 v15, v77, v29
    v_add_f32_dpp v14, v14, v14 quad_perm:[2,3,0,1] row_mask:0xf bank_mask:0xf
    v_dot2c_f32_bf16 v15, v78, v30
    v_dot2c_f32_bf16 v15, v79, v31
    v_add_f32_dpp v14, v14, v14 row_half_mirror row_mask:0xf bank_mask:0xf
    v_dot2c_f32_bf16 v15, v80, v32
    v_dot2c_f32_bf16 v15, v81, v33
    v_dot2c_f32_bf16 v15, v82, v34
    v_dot2c_f32_bf16 v15, v83, v35
    v_dot2c_f32_bf16 v15, v84, v36
    v_dot2c_f32_bf16 v15, v85, v37
    v_dot2c_f32_bf16 v15, v86, v38
    v_dot2c_f32_bf16 v15, v87, v39
    s_waitcnt vmcnt(14)
    buffer_load_dwordx4 v[76:79], v3, s[8:11], s44 offen offset:3072 nt
    buffer_load_dwordx4 v[80:83], v3, s[8:11], s44 offen offset:3200 nt
    buffer_load_dwordx4 v[84:87], v3, s[8:11], s44 offen offset:3328 nt
    s_add_u32 s44, s44, 393216
    v_mov_b32 v16, 0
    v_add_f32_dpp v15, v15, v15 quad_perm:[1,0,3,2] row_mask:0xf bank_mask:0xf
    v_dot2c_f32_bf16 v16, v88, v28
    v_dot2c_f32_bf16 v16, v89, v29
    v_add_f32_dpp v15, v15, v15 quad_perm:[2,3,0,1] row_mask:0xf bank_mask:0xf
    v_dot2c_f32_bf16 v16, v90, v30
    v_dot2c_f32_bf16 v16, v91, v31
    v_add_f32_dpp v15, v15, v15 row_half_mirror row_mask:0xf bank_mask:0xf
    v_dot2c_f32_bf16 v16, v92, v32
    v_cvt_pk_bf16_f32 v20, v14, v15
    v_dot2c_f32_bf16 v16, v93, v33
    v_dot2c_f32_bf16 v16, v94, v34
    v_dot2c_f32_bf16 v16, v95, v35
    v_dot2c_f32_bf16 v16, v96, v36
    v_dot2c_f32_bf16 v16, v97, v37
    v_dot2c_f32_bf16 v16, v98, v38
    v_dot2c_f32_bf16 v16, v99, v39
    s_waitcnt vmcnt(14)
    buffer_load_dwordx4 v[88:91], v3, s[8:11], s44 offen offset:0 nt
    buffer_load_dwordx4 v[92:95], v3, s[8:11], s44 offen offset:128 nt
    buffer_load_dwordx4 v[96:99], v3, s[8:11], s44 offen offset:256 nt
    v_mov_b32 v17, 0
    v_add_f32_dpp v16, v16, v16 quad_perm:[1,0,3,2] row_mask:0xf bank_mask:0xf
    v_dot2c_f32_bf16 v17, v100, v28
    v_dot2c_f32_bf16 v17, v101, v29
    v_add_f32_dpp v16, v16, v16 quad_perm:[2,3,0,1] row_mask:0xf bank_mask:0xf
    v_dot2c_f32_bf16 v17, v102, v30
    v_dot2c_f32_bf16 v17, v103, v31
    v_add_f32_dpp v16, v16, v16 row_half_mirror row_mask:0xf bank_mask:0xf
    v_dot2c_f32_bf16 v17, v104, v32
    v_dot2c_f32_bf16 v17, v105, v33
    v_dot2c_f32_bf16 v17, v106, v34
    v_dot2c_f32_bf16 v17, v107, v35
    v_dot2c_f32_bf16 v17, v108, v36
    v_dot2c_f32_bf16 v17, v109, v37
    v_dot2c_f32_bf16 v17, v110, v38
    v_dot2c_f32_bf16 v17, v111, v39
    s_waitcnt vmcnt(14)
    buffer_load_dwordx4 v[100:103], v3, s[8:11], s44 offen offset:3072 nt
    buffer_load_dwordx4 v[104:107], v3, s[8:11], s44 offen offset:3200 nt
    buffer_load_dwordx4 v[108:111], v3, s[8:11], s44 offen offset:3328 nt
    s_add_u32 s44, s44, 393216
    v_mov_b32 v14, 0
    v_add_f32_dpp v17, v17, v17 quad_perm:[1,0,3,2] row_mask:0xf bank_mask:0xf
    v_dot2c_f32_bf16 v14, v112, v28
    v_dot2c_f32_bf16 v14, v113, v29
    v_add_f32_dpp v17, v17, v17 quad_perm:[2,3,0,1] row_mask:0xf bank_mask:0xf
    v_dot2c_f32_bf16 v14, v114, v30
    v_dot2c_f32_bf16 v14, v115, v31
    v_add_f32_dpp v17, v17, v17 row_half_mirror row_mask:0xf bank_mask:0xf
    v_dot2c_f32_bf16 v14, v116, v32
    v_cvt_pk_bf16_f32 v21, v16, v17
    v_dot2c_f32_bf16 v14, v117, v33
    v_dot2c_f32_bf16 v14, v118, v34
    v_dot2c_f32_bf16 v14, v119, v35
    v_dot2c_f32_bf16 v14, v120, v36
    v_dot2c_f32_bf16 v14, v121, v37
    v_dot2c_f32_bf16 v14, v122, v38
    v_dot2c_f32_bf16 v14, v123, v39
    s_waitcnt vmcnt(14)
    buffer_load_dwordx4 v[112:115], v3, s[8:11], s44 offen offset:0 nt
    buffer_load_dwordx4 v[116:119], v3, s[8:11], s44 offen offset:128 nt
    buffer_load_dwordx4 v[120:123], v3, s[8:11], s44 offen offset:256 nt
    v_mov_b32 v15, 0
    v_add_f32_dpp v14, v14, v14 quad_perm:[1,0,3,2] row_mask:0xf bank_mask:0xf
    v_dot2c_f32_bf16 v15, v124, v28
    v_dot2c_f32_bf16 v15, v125, v29
    v_add_f32_dpp v14, v14, v14 quad_perm:[2,3,0,1] row_mask:0xf bank_mask:0xf
    v_dot2c_f32_bf16 v15, v126, v30
    v_dot2c_f32_bf16 v15, v127, v31
    v_add_f32_dpp v14, v14, v14 row_half_mirror row_mask:0xf bank_mask:0xf
    v_dot2c_f32_bf16 v15, v128, v32
    v_dot2c_f32_bf16 v15, v129, v33
    v_dot2c_f32_bf16 v15, v130, v34
    v_dot2c_f32_bf16 v15, v131, v35
    s_waitcnt vmcnt(15)
    v_readlane_b32 s93, v56, 63
    v_dot2c_f32_bf16 v15, v132, v36
    v_dot2c_f32_bf16 v15, v133, v37
    v_dot2c_f32_bf16 v15, v134, v38
    v_sub_u32 v56, v56, v57
    v_dot2c_f32_bf16 v15, v135, v39
    s_waitcnt vmcnt(12)
    buffer_load_dwordx4 v[124:127], v3, s[8:11], s44 offen offset:3072 nt
    buffer_load_dwordx4 v[128:131], v3, s[8:11], s44 offen offset:3200 nt
    buffer_load_dwordx4 v[132:135], v3, s[8:11], s44 offen offset:3328 nt
    s_add_u32 s44, s44, 393216
    v_add_u32 v57, 8, v56
    v_mov_b32 v16, 0
    v_add_f32_dpp v15, v15, v15 quad_perm:[1,0,3,2] row_mask:0xf bank_mask:0xf
    v_dot2c_f32_bf16 v16, v136, v28
    v_dot2c_f32_bf16 v16, v137, v29
    v_add_f32_dpp v15, v15, v15 quad_perm:[2,3,0,1] row_mask:0xf bank_mask:0xf
    v_dot2c_f32_bf16 v16, v138, v30
    v_cmp_gt_u32 vcc, 17, v57
    v_dot2c_f32_bf16 v16, v139, v31
    v_add_f32_dpp v15, v15, v15 row_half_mirror row_mask:0xf bank_mask:0xf
    s_nop 0
    v_lshl_add_u32 v56, v56, 1, 1
    v_dot2c_f32_bf16 v16, v140, v32
    v_cvt_pk_bf16_f32 v22, v14, v15
    v_dot2c_f32_bf16 v16, v141, v33
    v_dot2c_f32_bf16 v16, v142, v34
    v_cndmask_b32 v56, 0, v56, vcc
    v_dot2c_f32_bf16 v16, v143, v35
    s_nop 0
    v_add_u32_dpp v56, v56, v56 quad_perm:[1,0,3,2] row_mask:0xf bank_mask:0xf
    v_dot2c_f32_bf16 v16, v144, v36
    v_dot2c_f32_bf16 v16, v145, v37
    v_dot2c_f32_bf16 v16, v146, v38
    v_add_u32_dpp v56, v56, v56 quad_perm:[2,3,0,1] row_mask:0xf bank_mask:0xf
    v_dot2c_f32_bf16 v16, v147, v39
    s_waitcnt vmcnt(12)
    buffer_load_dwordx4 v[136:139], v3, s[8:11], s44 offen offset:0 nt
    buffer_load_dwordx4 v[140:143], v3, s[8:11], s44 offen offset:128 nt
    buffer_load_dwordx4 v[144:147], v3, s[8:11], s44 offen offset:256 nt
    v_add_u32_dpp v56, v56, v56 row_half_mirror row_mask:0xf bank_mask:0xf
    v_mov_b32 v17, 0
    v_add_f32_dpp v16, v16, v16 quad_perm:[1,0,3,2] row_mask:0xf bank_mask:0xf
    v_dot2c_f32_bf16 v17, v148, v28
    v_dot2c_f32_bf16 v17, v149, v29
    v_add_f32_dpp v16, v16, v16 quad_perm:[2,3,0,1] row_mask:0xf bank_mask:0xf
    v_dot2c_f32_bf16 v17, v150, v30
    v_add_u32_dpp v56, v56, v56 row_mirror row_mask:0xf bank_mask:0xf
    v_dot2c_f32_bf16 v17, v151, v31
    v_add_f32_dpp v16, v16, v16 row_half_mirror row_mask:0xf bank_mask:0xf
    s_nop 0
    v_readlane_b32 s88, v56, 0
    v_dot2c_f32_bf16 v17, v152, v32
    v_dot2c_f32_bf16 v17, v153, v33
    v_dot2c_f32_bf16 v17, v154, v34
    v_readlane_b32 s89, v56, 16
    v_dot2c_f32_bf16 v17, v155, v35
    s_nop 0
    v_readlane_b32 s90, v56, 32
    v_dot2c_f32_bf16 v17, v156, v36
    v_dot2c_f32_bf16 v17, v157, v37
    v_dot2c_f32_bf16 v17, v158, v38
    v_readlane_b32 s91, v56, 48
    v_dot2c_f32_bf16 v17, v159, v39
    s_nop 0
    s_nop 0
    s_nop 0
    v_add_f32_dpp v17, v17, v17 quad_perm:[1,0,3,2] row_mask:0xf bank_mask:0xf
    s_nop 0
    s_nop 0
    v_add_f32_dpp v17, v17, v17 quad_perm:[2,3,0,1] row_mask:0xf bank_mask:0xf
    s_nop 0
    s_nop 0
    v_add_f32_dpp v17, v17, v17 row_half_mirror row_mask:0xf bank_mask:0xf
    s_nop 0
    v_cvt_pk_bf16_f32 v23, v16, v17
    s_branch L_kb_end
L_kb1:
    s_waitcnt vmcnt(9)
    buffer_load_dwordx4 v[148:151], v3, s[8:11], s44 offen offset:3072 nt
    buffer_load_dwordx4 v[152:155], v3, s[8:11], s44 offen offset:3200 nt
    buffer_load_dwordx4 v[156:159], v3, s[8:11], s44 offen offset:3328 nt
    s_bitcmp1_b32 0x7f0000, s48
    s_cselect_b32 s45, s46, 393216
    s_cmp_eq_u32 s48, 7
    s_cselect_b32 s45, s47, s45
    s_cmp_eq_u32 s48, 15
    s_cselect_b32 s45, s42, s45
    s_cmp_eq_u32 s48, 23
    s_cselect_b32 s45, s43, s45
    s_cmp_eq_u32 s48, 31
    s_cselect_b32 s45, 0xed460000, s45
    s_cselect_b32 s8, s20, s8
    s_cselect_b32 s9, s21, s9
    s_add_u32 s44, s44, s45
    v_add_u32 v57, s60, v13
    buffer_store_dword v57, v58, s[12:15], s58 offen
    buffer_load_dword v56, v59, s[12:15], s59 offen sc1
    s_waitcnt lgkmcnt(0)
    v_mov_b32 v14, 0
    v_dot2c_f32_bf16 v14, v64, v28
    v_dot2c_f32_bf16 v14, v65, v29
    v_dot2c_f32_bf16 v14, v66, v30
    v_dot2c_f32_bf16 v14, v67, v31
    v_dot2c_f32_bf16 v14, v68, v32
    v_dot2c_f32_bf16 v14, v69, v33
    v_dot2c_f32_bf16 v14, v70, v34
    v_dot2c_f32_bf16 v14, v71, v35
    v_dot2c_f32_bf16 v14, v72, v36
    v_dot2c_f32_bf16 v14, v73, v37
    v_dot2c_f32_bf16 v14, v74, v38
    v_dot2c_f32_bf16 v14, v75, v39
    s_waitcnt vmcnt(11)
    buffer_load_dwordx4 v[64:67], v3, s[8:11], s44 offen offset:0 nt
    buffer_load_dwordx4 v[68:71], v3, s[8:11], s44 offen offset:128 nt
    buffer_load_dwordx4 v[72:75], v3, s[8:11], s44 offen offset:256 nt
    v_mov_b32 v15, 0
    v_add_f32_dpp v14, v14, v14 quad_perm:[1,0,3,2] row_mask:0xf bank_mask:0xf
    v_dot2c_f32_bf16 v15, v76, v28
    v_dot2c_f32_bf16 v15, v77, v29
    v_add_f32_dpp v14, v14, v14 quad_perm:[2,3,0,1] row_mask:0xf bank_mask:0xf
    v_dot2c_f32_bf16 v15, v78, v30
    v_dot2c_f32_bf16 v15, v79, v31
    v_add_f32_dpp v14, v14, v14 row_half_mirror row_mask:0xf bank_mask:0xf
    v_dot2c_f32_bf16 v15, v80, v32
    v_dot2c_f32_bf16 v15, v81, v33
    v_dot2c_f32_bf16 v15, v82, v34
    v_dot2c_f32_bf16 v15, v83, v35
    v_dot2c_f32_bf16 v15, v84, v36
    v_dot2c_f32_bf16 v15, v85, v37
    v_dot2c_f32_bf16 v15, v86, v38
    v_dot2c_f32_bf16 v15, v87, v39
    s_waitcnt vmcnt(11)
    buffer_load_dwordx4 v[76:79], v3, s[8:11], s44 offen offset:3072 nt
    buffer_load_dwordx4 v[80:83], v3, s[8:11], s44 offen offset:3200 nt
    buffer_load_dwordx4 v[84:87], v3, s[8:11], s44 offen offset:3328 nt
    s_add_u32 s44, s44, 393216
    v_mov_b32 v16, 0
    v_add_f32_dpp v15, v15, v15 quad_perm:[1,0,3,2] row_mask:0xf bank_mask:0xf
    v_dot2c_f32_bf16 v16, v88, v28
    v_dot2c_f32_bf16 v16, v89, v29
    v_add_f32_dpp v15, v15, v15 quad_perm:[2,3,0,1] row_mask:0xf bank_mask:0xf
    v_dot2c_f32_bf16 v16, v90, v30
    v_dot2c_f32_bf16 v16, v91, v31
    v_add_f32_dpp v15, v15, v15 row_half_mirror row_mask:0xf bank_mask:0xf
    v_dot2c_f32_bf16 v16, v92, v32
    v_cvt_pk_bf16_f32 v20, v14, v15
    v_dot2c_f32_bf16 v16, v93, v33
    v_dot2c_f32_bf16 v16, v94, v34
    v_dot2c_f32_bf16 v16, v95, v35
    v_dot2c_f32_bf16 v16, v96, v36
    v_dot2c_f32_bf16 v16, v97, v37
    v_dot2c_f32_bf16 v16, v98, v38
    v_dot2c_f32_bf16 v16, v99, v39
    s_waitcnt vmcnt(11)
    buffer_load_dwordx4 v[88:91], v3, s[8:11], s44 offen offset:0 nt
    buffer_load_dwordx4 v[92:95], v3, s[8:11], s44 offen offset:128 nt
    buffer_load_dwordx4 v[96:99], v3, s[8:11], s44 offen offset:256 nt
    v_mov_b32 v17, 0
    v_add_f32_dpp v16, v16, v16 quad_perm:[1,0,3,2] row_mask:0xf bank_mask:0xf
    v_dot2c_f32_bf16 v17, v100, v28
    v_dot2c_f32_bf16 v17, v101, v29
    v_add_f32_dpp v16, v16, v16 quad_perm:[2,3,0,1] row_mask:0xf bank_mask:0xf
    v_dot2c_f32_bf16 v17, v102, v30
    v_dot2c_f32_bf16 v17, v103, v31
    v_add_f32_dpp v16, v16, v16 row_half_mirror row_mask:0xf bank_mask:0xf
    v_dot2c_f32_bf16 v17, v104, v32
    v_dot2c_f32_bf16 v17, v105, v33
    v_dot2c_f32_bf16 v17, v106, v34
    v_dot2c_f32_bf16 v17, v107, v35
    v_dot2c_f32_bf16 v17, v108, v36
    v_dot2c_f32_bf16 v17, v109, v37
    v_dot2c_f32_bf16 v17, v110, v38
    v_dot2c_f32_bf16 v17, v111, v39
    s_waitcnt vmcnt(11)
    buffer_load_dwordx4 v[100:103], v3, s[8:11], s44 offen offset:3072 nt
    buffer_load_dwordx4 v[104:107], v3, s[8:11], s44 offen offset:3200 nt
    buffer_load_dwordx4 v[108:111], v3, s[8:11], s44 offen offset:3328 nt
    s_add_u32 s44, s44, 393216
    v_mov_b32 v14, 0
    v_add_f32_dpp v17, v17, v17 quad_perm:[1,0,3,2] row_mask:0xf bank_mask:0xf
    v_dot2c_f32_bf16 v14, v112, v28
    v_dot2c_f32_bf16 v14, v113, v29
    v_add_f32_dpp v17, v17, v17 quad_perm:[2,3,0,1] row_mask:0xf bank_mask:0xf
    v_dot2c_f32_bf16 v14, v114, v30
    v_dot2c_f32_bf16 v14, v115, v31
    v_add_f32_dpp v17, v17, v17 row_half_mirror row_mask:0xf bank_mask:0xf
    v_dot2c_f32_bf16 v14, v116, v32
    v_cvt_pk_bf16_f32 v21, v16, v17
    v_dot2c_f32_bf16 v14, v117, v33
    v_dot2c_f32_bf16 v14, v118, v34
    v_dot2c_f32_bf16 v14, v119, v35
    v_dot2c_f32_bf16 v14, v120, v36
    v_dot2c_f32_bf16 v14, v121, v37
    v_dot2c_f32_bf16 v14, v122, v38
    v_dot2c_f32_bf16 v14, v123, v39
    s_waitcnt vmcnt(9)
    buffer_load_dwordx4 v[112:115], v3, s[8:11], s44 offen offset:0 nt
    buffer_load_dwordx4 v[116:119], v3, s[8:11], s44 offen offset:128 nt
    buffer_load_dwordx4 v[120:123], v3, s[8:11], s44 offen offset:256 nt
    v_mov_b32 v15, 0
    v_add_f32_dpp v14, v14, v14 quad_perm:[1,0,3,2] row_mask:0xf bank_mask:0xf
    v_dot2c_f32_bf16 v15, v124, v28
    v_dot2c_f32_bf16 v15, v125, v29
    v_add_f32_dpp v14, v14, v14 quad_perm:[2,3,0,1] row_mask:0xf bank_mask:0xf
    v_dot2c_f32_bf16 v15, v126, v30
    v_dot2c_f32_bf16 v15, v127, v31
    v_add_f32_dpp v14, v14, v14 row_half_mirror row_mask:0xf bank_mask:0xf
    v_dot2c_f32_bf16 v15, v128, v32
    v_dot2c_f32_bf16 v15, v129, v33
    v_dot2c_f32_bf16 v15, v130, v34
    v_dot2c_f32_bf16 v15, v131, v35
    s_waitcnt vmcnt(15)
    v_readlane_b32 s93, v56, 63
    v_dot2c_f32_bf16 v15, v132, v36
    v_dot2c_f32_bf16 v15, v133, v37
    v_dot2c_f32_bf16 v15, v134, v38
    v_sub_u32 v56, v56, v57
    v_dot2c_f32_bf16 v15, v135, v39
    s_waitcnt vmcnt(9)
    buffer_load_dwordx4 v[124:127], v3, s[8:11], s44 offen offset:3072 nt
    buffer_load_dwordx4 v[128:131], v3, s[8:11], s44 offen offset:3200 nt
    buffer_load_dwordx4 v[132:135], v3, s[8:11], s44 offen offset:3328 nt
    s_add_u32 s44, s44, 393216
    v_add_u32 v57, 8, v56
    v_mov_b32 v16, 0
    v_add_f32_dpp v15, v15, v15 quad_perm:[1,0,3,2] row_mask:0xf bank_mask:0xf
    v_dot2c_f32_bf16 v16, v136, v28
    v_dot2c_f32_bf16 v16, v137, v29
    v_add_f32_dpp v15, v15, v15 quad_perm:[2,3,0,1] row_mask:0xf bank_mask:0xf
    v_dot2c_f32_bf16 v16, v138, v30
    v_cmp_gt_u32 vcc, 17, v57
    v_dot2c_f32_bf16 v16, v139, v31
    v_add_f32_dpp v15, v15, v15 row_half_mirror row_mask:0xf bank_mask:0xf
    s_nop 0
    v_lshl_add_u32 v56, v56, 1, 1
    v_dot2c_f32_bf16 v16, v140, v32
    v_cvt_pk_bf16_f32 v22, v14, v15
    v_dot2c_f32_bf16 v16, v141, v33
    v_dot2c_f32_bf16 v16, v142, v34
    v_cndmask_b32 v56, 0, v56, vcc
    v_dot2c_f32_bf16 v16, v143, v35
    s_nop 0
    v_add_u32_dpp v56, v56, v56 quad_perm:[1,0,3,2] row_mask:0xf bank_mask:0xf
    v_dot2c_f32_bf16 v16, v144, v36
    v_dot2c_f32_bf16 v16, v145, v37
    v_dot2c_f32_bf16 v16, v146, v38
    v_add_u32_dpp v56, v56, v56 quad_perm:[2,3,0,1] row_mask:0xf bank_mask:0xf
    v_dot2c_f32_bf16 v16, v147, v39
    s_waitcnt vmcnt(9)
    buffer_load_dwordx4 v[136:139], v3, s[8:11], s44 offen offset:0 nt
    buffer_load_dwordx4 v[140:143], v3, s[8:11], s44 offen offset:128 nt
    buffer_load_dwordx4 v[144:147], v3, s[8:11], s44 offen offset:256 nt
    v_add_u32_dpp v56, v56, v56 row_half_mirror row_mask:0xf bank_mask:0xf
    v_mov_b32 v17, 0
    v_add_f32_dpp v16, v16, v16 quad_perm:[1,0,3,2] row_mask:0xf bank_mask:0xf
    v_dot2c_f32_bf16 v17, v148, v28
    v_dot2c_f32_bf16 v17, v149, v29
    v_add_f32_dpp v16, v16, v16 quad_perm:[2,3,0,1] row_mask:0xf bank_mask:0xf
    v_dot2c_f32_bf16 v17, v150, v30
    v_add_u32_dpp v56, v56, v56 row_mirror row_mask:0xf bank_mask:0xf
    v_dot2c_f32_bf16 v17, v151, v31
    v_add_f32_dpp v16, v16, v16 row_half_mirror row_mask:0xf bank_mask:0xf
    s_nop 0
    v_readlane_b32 s88, v56, 0
    v_dot2c_f32_bf16 v17, v152, v32
    v_dot2c_f32_bf16 v17, v153, v33
    v_dot2c_f32_bf16 v17, v154, v34
    v_readlane_b32 s89, v56, 16
    v_dot2c_f32_bf16 v17, v155, v35
    s_nop 0
    v_readlane_b32 s90, v56, 32
    v_dot2c_f32_bf16 v17, v156, v36
    v_dot2c_f32_bf16 v17, v157, v37
    v_dot2c_f32_bf16 v17, v158, v38
    v_readlane_b32 s91, v56, 48
    v_dot2c_f32_bf16 v17, v159, v39
    s_nop 0
    s_nop 0
    s_nop 0
    v_add_f32_dpp v17, v17, v17 quad_perm:[1,0,3,2] row_mask:0xf bank_mask:0xf
    s_nop 0
    s_nop 0
    v_add_f32_dpp v17, v17, v17 quad_perm:[2,3,0,1] row_mask:0xf bank_mask:0xf
    s_nop 0
    s_nop 0
    v_add_f32_dpp v17, v17, v17 row_half_mirror row_mask:0xf bank_mask:0xf
    s_nop 0
    v_cvt_pk_bf16_f32 v23, v16, v17
L_kb_end:
    s_add_u32 s88, s88, s89
    s_add_u32 s90, s90, s91
    s_add_u32 s88, s88, s90
    s_sub_u32 s93, s93, s55
    s_sub_u32 s89, s93, 128
    s_cmp_lt_u32 s93, 256
    s_cselect_b32 s89, s89, 0
    s_add_u32 s88, s88, s89
    s_mov_b32 s53, 1
    s_cmp_gt_i32 s88, 45
    s_cselect_b32 s53, 2, s53
    s_cmp_lt_i32 s88, -45
    s_cselect_b32 s53, 0, s53
L_nolevel_7:
    ds_write_b128 v4, v[20:23] offset:0
    v_add_u32 v13, 1, v13
    v_add_u32 v4, 256, v4
    ds_write_b32 v7, v13 offset:8
    s_bitcmp1_b32 0xff8080, s48
    s_cbranch_scc0 L_ksame
    s_cmp_gt_u32 s48, 15
    s_cbranch_scc1 L_kready
    s_lshr_b32 s50, s48, 3
    s_add_u32 s50, s50, 2
    s_mov_b32 s62, 4000000
    v_mov_b32 v12, 0
L_wl_8:
    ds_read_b32 v8, v12 offset:16
    s_waitcnt lgkmcnt(0)
    s_nop 0
    v_readfirstlane_b32 s63, v8
    s_cmp_ge_u32 s63, s50
    s_cbranch_scc1 L_wlok_9
    s_sub_u32 s62, s62, 1
    s_cmp_lg_u32 s62, 0
    s_cbranch_scc1 L_wl_8
    s_endpgm
L_wlok_9:
L_kready:
    ds_read_b128 v[28:31], v5 offset:64
    ds_read_b128 v[32:35], v5 offset:192
    ds_read_b128 v[36:39], v5 offset:320
    v_add_u32 v5, 384, v5
L_ksame:
    s_add_u32 s48, s48, 1
    s_cmp_lt_u32 s48, 32
    s_cbranch_scc1 L_kloop
    v_subrev_u32 v4, 8192, v4
    s_mov_b32 s62, 4000000
    v_mov_b32 v12, 0
L_wl_10:
    ds_read_b32 v8, v12 offset:20
    s_waitcnt lgkmcnt(0)
    s_nop 0
    v_readfirstlane_b32 s63, v8
    s_cmp_ge_u32 s63, 2
    s_cbranch_scc1 L_wlok_11
    s_sub_u32 s62, s62, 1
    s_cmp_lg_u32 s62, 0
    s_cbranch_scc1 L_wl_10
    s_endpgm
L_wlok_11:
    ds_read_b32 v14, v12 offset:48
    ds_read_b128 v[52:55], v4
    v_add_u32 v4, 256, v4
    v_mov_b32 v28, 0
    v_mov_b32 v29, 0
    v_mov_b32 v30, 0
    v_mov_b32 v31, 0
    v_mov_b32 v32, 0
    v_mov_b32 v33, 0
    v_mov_b32 v34, 0
    v_mov_b32 v35, 0
    v_mov_b32 v36, 0
    v_mov_b32 v37, 0
    v_mov_b32 v38, 0
    v_mov_b32 v39, 0
    v_mov_b32 v40, 0
    v_mov_b32 v41, 0
    v_mov_b32 v42, 0
    v_mov_b32 v43, 0
    v_mov_b32 v44, 0
    v_mov_b32 v45, 0
    v_mov_b32 v46, 0
    v_mov_b32 v47, 0
    v_mov_b32 v48, 0
    v_mov_b32 v49, 0
    v_mov_b32 v50, 0
    v_mov_b32 v51, 0
    v_mov_b32 v15, 0
    s_mov_b32 s48, 0
    s_mov_b32 s49, 0
    s_mov_b32 s50, 0
    s_mov_b32 s52, 0
L_vloop:
    s_cmp_eq_u32 s53, 1
    s_cbranch_scc1 L_vb1
    s_cmp_eq_u32 s53, 2
    s_cbranch_scc1 L_vb2
L_vb0:
    s_waitcnt vmcnt(6)
    buffer_load_dwordx4 v[148:151], v3, s[8:11], s44 offen offset:3072 nt
    buffer_load_dwordx4 v[152:155], v3, s[8:11], s44 offen offset:3200 nt
    buffer_load_dwordx4 v[156:159], v3, s[8:11], s44 offen offset:3328 nt
    s_bitcmp1_b32 0x7f0000, s48
    s_cselect_b32 s45, s46, 393216
    s_cmp_eq_u32 s48, 7
    s_cselect_b32 s45, s47, s45
    s_cmp_eq_u32 s48, 15
    s_cselect_b32 s45, s42, s45
    s_cmp_eq_u32 s48, 23
    s_cselect_b32 s45, s43, s45
    s_add_u32 s44, s44, s45
    v_add_u32 v57, s60, v13
    buffer_store_dword v57, v58, s[12:15], s58 offen
    buffer_load_dword v56, v59, s[12:15], s59 offen sc1
    s_waitcnt lgkmcnt(0)
    v_readfirstlane_b32 s63, v15
    s_cmp_ge_u32 s63, s52
    s_cbranch_scc1 L_vok_12
    s_mov_b32 s62, 4000000
    v_mov_b32 v12, 0
L_wl_14:
    ds_read_b32 v8, v12 offset:52
    s_waitcnt lgkmcnt(0)
    s_nop 0
    v_readfirstlane_b32 s63, v8
    s_cmp_ge_u32 s63, s52
    s_cbranch_scc1 L_wlok_15
    s_sub_u32 s62, s62, 1
    s_cmp_lg_u32 s62, 0
    s_cbranch_scc1 L_wl_14
    s_endpgm
L_wlok_15:
L_vok_12:
    s_bitcmp1_b32 0x1ff0100, s48
    s_cbranch_scc0 L_vnd_13
    v_add_u32 v9, s49, v6
    s_add_u32 s50, s50, 1
    ds_write_b128 v9, v[28:31] offset:0
    ds_write_b128 v9, v[32:35] offset:16
    ds_write_b128 v9, v[36:39] offset:256
    ds_write_b128 v9, v[40:43] offset:272
    ds_write_b128 v9, v[44:47] offset:512
    ds_write_b128 v9, v[48:51] offset:528
    v_mov_b32 v8, s50
    ds_write_b32 v7, v8 offset:0
    s_add_u32 s49, s49, 12288
    s_cmp_eq_u32 s49, 36864
    s_cselect_b32 s49, 0, s49
    v_mov_b32 v28, 0
    v_mov_b32 v29, 0
    v_mov_b32 v30, 0
    v_mov_b32 v31, 0
    v_mov_b32 v32, 0
    v_mov_b32 v33, 0
    v_mov_b32 v34, 0
    v_mov_b32 v35, 0
    v_mov_b32 v36, 0
    v_mov_b32 v37, 0
    v_mov_b32 v38, 0
    v_mov_b32 v39, 0
    v_mov_b32 v40, 0
    v_mov_b32 v41, 0
    v_mov_b32 v42, 0
    v_mov_b32 v43, 0
    v_mov_b32 v44, 0
    v_mov_b32 v45, 0
    v_mov_b32 v46, 0
    v_mov_b32 v47, 0
    v_mov_b32 v48, 0
    v_mov_b32 v49, 0
    v_mov_b32 v50, 0
    v_mov_b32 v51, 0
L_vnd_13:
    v_and_b32 v60, 0xffff, v52
    v_lshlrev_b32 v61, 16, v52
    v_lshrrev_b32 v62, 16, v52
    v_and_b32 v63, 0xffff0000, v52
    v_dot2c_f32_bf16 v28, v64, v60
    v_dot2c_f32_bf16 v29, v64, v61
    v_dot2c_f32_bf16 v30, v65, v60
    v_dot2c_f32_bf16 v31, v65, v61
    v_dot2c_f32_bf16 v32, v66, v60
    v_dot2c_f32_bf16 v33, v66, v61
    v_dot2c_f32_bf16 v34, v67, v60
    v_dot2c_f32_bf16 v35, v67, v61
    v_dot2c_f32_bf16 v36, v68, v60
    v_dot2c_f32_bf16 v37, v68, v61
    v_dot2c_f32_bf16 v38, v69, v60
    v_dot2c_f32_bf16 v39, v69, v61
    v_dot2c_f32_bf16 v40, v70, v60
    v_dot2c_f32_bf16 v41, v70, v61
    v_dot2c_f32_bf16 v42, v71, v60
    v_dot2c_f32_bf16 v43, v71, v61
    v_dot2c_f32_bf16 v44, v72, v60
    v_dot2c_f32_bf16 v45, v72, v61
    v_dot2c_f32_bf16 v46, v73, v60
    v_dot2c_f32_bf16 v47, v73, v61
    v_dot2c_f32_bf16 v48, v74, v60
    v_dot2c_f32_bf16 v49, v74, v61
    v_dot2c_f32_bf16 v50, v75, v60
    v_dot2c_f32_bf16 v51, v75, v61
    s_waitcnt vmcnt(8)
    buffer_load_dwordx4 v[64:67], v3, s[8:11], s44 offen offset:0 nt
    buffer_load_dwordx4 v[68:71], v3, s[8:11], s44 offen offset:128 nt
    buffer_load_dwordx4 v[72:75], v3, s[8:11], s44 offen offset:256 nt
    v_dot2c_f32_bf16 v28, v76, v62
    v_dot2c_f32_bf16 v29, v76, v63
    v_dot2c_f32_bf16 v30, v77, v62
    v_dot2c_f32_bf16 v31, v77, v63
    v_dot2c_f32_bf16 v32, v78, v62
    v_dot2c_f32_bf16 v33, v78, v63
    v_dot2c_f32_bf16 v34, v79, v62
    v_dot2c_f32_bf16 v35, v79, v63
    v_dot2c_f32_bf16 v36, v80, v62
    v_dot2c_f32_bf16 v37, v80, v63
    v_dot2c_f32_bf16 v38, v81, v62
    v_dot2c_f32_bf16 v39, v81, v63
    v_dot2c_f32_bf16 v40, v82, v62
    v_dot2c_f32_bf16 v41, v82, v63
    v_dot2c_f32_bf16 v42, v83, v62
    v_dot2c_f32_bf16 v43, v83, v63
    v_dot2c_f32_bf16 v44, v84, v62
    v_dot2c_f32_bf16 v45, v84, v63
    v_dot2c_f32_bf16 v46, v85, v62
    v_dot2c_f32_bf16 v47, v85, v63
    v_dot2c_f32_bf16 v48, v86, v62
    v_dot2c_f32_bf16 v49, v86, v63
    v_dot2c_f32_bf16 v50, v87, v62
    v_dot2c_f32_bf16 v51, v87, v63
    s_waitcnt vmcnt(8)
    buffer_load_dwordx4 v[76:79], v3, s[8:11], s44 offen offset:3072 nt
    buffer_load_dwordx4 v[80:83], v3, s[8:11], s44 offen offset:3200 nt
    buffer_load_dwordx4 v[84:87], v3, s[8:11], s44 offen offset:3328 nt
    s_add_u32 s44, s44, 393216
    v_and_b32 v60, 0xffff, v53
    v_lshlrev_b32 v61, 16, v53
    v_lshrrev_b32 v62, 16, v53
    v_and_b32 v63, 0xffff0000, v53
    v_dot2c_f32_bf16 v28, v88, v60
    v_dot2c_f32_bf16 v29, v88, v61
    v_dot2c_f32_bf16 v30, v89, v60
    v_dot2c_f32_bf16 v31, v89, v61
    v_dot2c_f32_bf16 v32, v90, v60
    v_dot2c_f32_bf16 v33, v90, v61
    v_dot2c_f32_bf16 v34, v91, v60
    v_dot2c_f32_bf16 v35, v91, v61
    v_dot2c_f32_bf16 v36, v92, v60
    v_dot2c_f32_bf16 v37, v92, v61
    v_dot2c_f32_bf16 v38, v93, v60
    v_dot2c_f32_bf16 v39, v93, v61
    v_dot2c_f32_bf16 v40, v94, v60
    v_dot2c_f32_bf16 v41, v94, v61
    v_dot2c_f32_bf16 v42, v95, v60
    v_dot2c_f32_bf16 v43, v95, v61
    v_dot2c_f32_bf16 v44, v96, v60
    v_dot2c_f32_bf16 v45, v96, v61
    v_dot2c_f32_bf16 v46, v97, v60
    v_dot2c_f32_bf16 v47, v97, v61
    v_dot2c_f32_bf16 v48, v98, v60
    v_dot2c_f32_bf16 v49, v98, v61
    v_dot2c_f32_bf16 v50, v99, v60
    v_dot2c_f32_bf16 v51, v99, v61
    s_waitcnt vmcnt(8)
    buffer_load_dwordx4 v[88:91], v3, s[8:11], s44 offen offset:0 nt
    buffer_load_dwordx4 v[92:95], v3, s[8:11], s44 offen offset:128 nt
    buffer_load_dwordx4 v[96:99], v3, s[8:11], s44 offen offset:256 nt
    v_dot2c_f32_bf16 v28, v100, v62
    v_dot2c_f32_bf16 v29, v100, v63
    v_dot2c_f32_bf16 v30, v101, v62
    v_dot2c_f32_bf16 v31, v101, v63
    v_dot2c_f32_bf16 v32, v102, v62
    v_dot2c_f32_bf16 v33, v102, v63
    v_dot2c_f32_bf16 v34, v103, v62
    v_dot2c_f32_bf16 v35, v103, v63
    v_dot2c_f32_bf16 v36, v104, v62
    v_dot2c_f32_bf16 v37, v104, v63
    v_dot2c_f32_bf16 v38, v105, v62
    v_dot2c_f32_bf16 v39, v105, v63
    v_dot2c_f32_bf16 v40, v106, v62
    v_dot2c_f32_bf16 v41, v106, v63
    v_dot2c_f32_bf16 v42, v107, v62
    v_dot2c_f32_bf16 v43, v107, v63
    v_dot2c_f32_bf16 v44, v108, v62
    v_dot2c_f32_bf16 v45, v108, v63
    v_dot2c_f32_bf16 v46, v109, v62
    v_dot2c_f32_bf16 v47, v109, v63
    v_dot2c_f32_bf16 v48, v110, v62
    v_dot2c_f32_bf16 v49, v110, v63
    v_dot2c_f32_bf16 v50, v111, v62
    v_dot2c_f32_bf16 v51, v111, v63
    s_waitcnt vmcnt(6)
    buffer_load_dwordx4 v[100:103], v3, s[8:11], s44 offen offset:3072 nt
    buffer_load_dwordx4 v[104:107], v3, s[8:11], s44 offen offset:3200 nt
    buffer_load_dwordx4 v[108:111], v3, s[8:11], s44 offen offset:3328 nt
    s_add_u32 s44, s44, 393216
    v_and_b32 v60, 0xffff, v54
    v_lshlrev_b32 v61, 16, v54
    v_lshrrev_b32 v62, 16, v54
    v_and_b32 v63, 0xffff0000, v54
    v_dot2c_f32_bf16 v28, v112, v60
    v_dot2c_f32_bf16 v29, v112, v61
    v_dot2c_f32_bf16 v30, v113, v60
    v_dot2c_f32_bf16 v31, v113, v61
    v_dot2c_f32_bf16 v32, v114, v60
    v_dot2c_f32_bf16 v33, v114, v61
    v_dot2c_f32_bf16 v34, v115, v60
    v_dot2c_f32_bf16 v35, v115, v61
    v_dot2c_f32_bf16 v36, v116, v60
    v_dot2c_f32_bf16 v37, v116, v61
    v_dot2c_f32_bf16 v38, v117, v60
    v_dot2c_f32_bf16 v39, v117, v61
    v_dot2c_f32_bf16 v40, v118, v60
    v_dot2c_f32_bf16 v41, v118, v61
    v_dot2c_f32_bf16 v42, v119, v60
    v_dot2c_f32_bf16 v43, v119, v61
    v_dot2c_f32_bf16 v44, v120, v60
    v_dot2c_f32_bf16 v45, v120, v61
    v_dot2c_f32_bf16 v46, v121, v60
    v_dot2c_f32_bf16 v47, v121, v61
    v_dot2c_f32_bf16 v48, v122, v60
    v_dot2c_f32_bf16 v49, v122, v61
    v_dot2c_f32_bf16 v50, v123, v60
    v_dot2c_f32_bf16 v51, v123, v61
    s_waitcnt vmcnt(6)
    buffer_load_dwordx4 v[112:115], v3, s[8:11], s44 offen offset:0 nt
    buffer_load_dwordx4 v[116:119], v3, s[8:11], s44 offen offset:128 nt
    buffer_load_dwordx4 v[120:123], v3, s[8:11], s44 offen offset:256 nt
    v_dot2c_f32_bf16 v28, v124, v62
    v_dot2c_f32_bf16 v29, v124, v63
    v_dot2c_f32_bf16 v30, v125, v62
    v_dot2c_f32_bf16 v31, v125, v63
    v_dot2c_f32_bf16 v32, v126, v62
    v_dot2c_f32_bf16 v33, v126, v63
    v_dot2c_f32_bf16 v34, v127, v62
    v_dot2c_f32_bf16 v35, v127, v63
    v_dot2c_f32_bf16 v36, v128, v62
    v_dot2c_f32_bf16 v37, v128, v63
    v_dot2c_f32_bf16 v38, v129, v62
    v_dot2c_f32_bf16 v39, v129, v63
    v_dot2c_f32_bf16 v40, v130, v62
    v_dot2c_f32_bf16 v41, v130, v63
    v_dot2c_f32_bf16 v42, v131, v62
    v_dot2c_f32_bf16 v43, v131, v63
    s_waitcnt vmcnt(15)
    v_readlane_b32 s93, v56, 63
    v_dot2c_f32_bf16 v44, v132, v62
    v_dot2c_f32_bf16 v45, v132, v63
    v_dot2c_f32_bf16 v46, v133, v62
    v_dot2c_f32_bf16 v47, v133, v63
    v_dot2c_f32_bf16 v48, v134, v62
    v_dot2c_f32_bf16 v49, v134, v63
    v_dot2c_f32_bf16 v50, v135, v62
    v_dot2c_f32_bf16 v51, v135, v63
    v_sub_u32 v56, v56, v57
    s_waitcnt vmcnt(6)
    buffer_load_dwordx4 v[124:127], v3, s[8:11], s44 offen offset:3072 nt
    buffer_load_dwordx4 v[128:131], v3, s[8:11], s44 offen offset:3200 nt
    buffer_load_dwordx4 v[132:135], v3, s[8:11], s44 offen offset:3328 nt
    s_add_u32 s44, s44, 393216
    v_add_u32 v57, 8, v56
    v_and_b32 v60, 0xffff, v55
    v_lshlrev_b32 v61, 16, v55
    v_lshrrev_b32 v62, 16, v55
    v_and_b32 v63, 0xffff0000, v55
    v_add_u32 v13, 1, v13
    ds_write_b32 v7, v13 offset:8
    ds_read_b32 v15, v12 offset:52
    ds_read_b128 v[52:55], v4 offset:0
    v_add_u32 v4, 256, v4
    v_dot2c_f32_bf16 v28, v136, v60
    v_dot2c_f32_bf16 v29, v136, v61
    v_dot2c_f32_bf16 v30, v137, v60
    v_dot2c_f32_bf16 v31, v137, v61
    v_dot2c_f32_bf16 v32, v138, v60
    v_dot2c_f32_bf16 v33, v138, v61
    v_dot2c_f32_bf16 v34, v139, v60
    v_dot2c_f32_bf16 v35, v139, v61
    v_cmp_gt_u32 vcc, 17, v57
    s_nop 1
    v_lshl_add_u32 v56, v56, 1, 1
    v_dot2c_f32_bf16 v36, v140, v60
    v_dot2c_f32_bf16 v37, v140, v61
    v_dot2c_f32_bf16 v38, v141, v60
    v_dot2c_f32_bf16 v39, v141, v61
    v_dot2c_f32_bf16 v40, v142, v60
    v_dot2c_f32_bf16 v41, v142, v61
    v_dot2c_f32_bf16 v42, v143, v60
    v_dot2c_f32_bf16 v43, v143, v61
    v_cndmask_b32 v56, 0, v56, vcc
    s_nop 1
    v_add_u32_dpp v56, v56, v56 quad_perm:[1,0,3,2] row_mask:0xf bank_mask:0xf
    v_dot2c_f32_bf16 v44, v144, v60
    v_dot2c_f32_bf16 v45, v144, v61
    v_dot2c_f32_bf16 v46, v145, v60
    v_dot2c_f32_bf16 v47, v145, v61
    v_dot2c_f32_bf16 v48, v146, v60
    v_dot2c_f32_bf16 v49, v146, v61
    v_dot2c_f32_bf16 v50, v147, v60
    v_dot2c_f32_bf16 v51, v147, v61
    v_add_u32_dpp v56, v56, v56 quad_perm:[2,3,0,1] row_mask:0xf bank_mask:0xf
    s_waitcnt vmcnt(6)
    buffer_load_dwordx4 v[136:139], v3, s[8:11], s44 offen offset:0 nt
    buffer_load_dwordx4 v[140:143], v3, s[8:11], s44 offen offset:128 nt
    buffer_load_dwordx4 v[144:147], v3, s[8:11], s44 offen offset:256 nt
    v_add_u32_dpp v56, v56, v56 row_half_mirror row_mask:0xf bank_mask:0xf
    v_dot2c_f32_bf16 v28, v148, v62
    v_dot2c_f32_bf16 v29, v148, v63
    v_dot2c_f32_bf16 v30, v149, v62
    v_dot2c_f32_bf16 v31, v149, v63
    v_dot2c_f32_bf16 v32, v150, v62
    v_dot2c_f32_bf16 v33, v150, v63
    v_dot2c_f32_bf16 v34, v151, v62
    v_dot2c_f32_bf16 v35, v151, v63
    v_add_u32_dpp v56, v56, v56 row_mirror row_mask:0xf bank_mask:0xf
    s_nop 1
    v_readlane_b32 s88, v56, 0
    v_dot2c_f32_bf16 v36, v152, v62
    v_dot2c_f32_bf16 v37, v152, v63
    v_dot2c_f32_bf16 v38, v153, v62
    v_dot2c_f32_bf16 v39, v153, v63
    v_dot2c_f32_bf16 v40, v154, v62
    v_dot2c_f32_bf16 v41, v154, v63
    v_dot2c_f32_bf16 v42, v155, v62
    v_dot2c_f32_bf16 v43, v155, v63
    v_readlane_b32 s89, v56, 16
    s_nop 1
    v_readlane_b32 s90, v56, 32
    v_dot2c_f32_bf16 v44, v156, v62
    v_dot2c_f32_bf16 v45, v156, v63
    v_dot2c_f32_bf16 v46, v157, v62
    v_dot2c_f32_bf16 v47, v157, v63
    v_dot2c_f32_bf16 v48, v158, v62
    v_dot2c_f32_bf16 v49, v158, v63
    v_dot2c_f32_bf16 v50, v159, v62
    v_dot2c_f32_bf16 v51, v159, v63
    v_readlane_b32 s91, v56, 48
    s_branch L_vb_end
L_vb2:
    s_waitcnt vmcnt(12)
    buffer_load_dwordx4 v[148:151], v3, s[8:11], s44 offen offset:3072 nt
    buffer_load_dwordx4 v[152:155], v3, s[8:11], s44 offen offset:3200 nt
    buffer_load_dwordx4 v[156:159], v3, s[8:11], s44 offen offset:3328 nt
    s_bitcmp1_b32 0x7f0000, s48
    s_cselect_b32 s45, s46, 393216
    s_cmp_eq_u32 s48, 7
    s_cselect_b32 s45, s47, s45
    s_cmp_eq_u32 s48, 15
    s_cselect_b32 s45, s42, s45
    s_cmp_eq_u32 s48, 23
    s_cselect_b32 s45, s43, s45
    s_add_u32 s44, s44, s45
    v_add_u32 v57, s60, v13
    buffer_store_dword v57, v58, s[12:15], s58 offen
    buffer_load_dword v56, v59, s[12:15], s59 offen sc1
    s_waitcnt lgkmcnt(0)
    v_readfirstlane_b32 s63, v15
    s_cmp_ge_u32 s63, s52
    s_cbranch_scc1 L_vok_16
    s_mov_b32 s62, 4000000
    v_mov_b32 v12, 0
L_wl_18:
    ds_read_b32 v8, v12 offset:52
    s_waitcnt lgkmcnt(0)
    s_nop 0
    v_readfirstlane_b32 s63, v8
    s_cmp_ge_u32 s63, s52
    s_cbranch_scc1 L_wlok_19
    s_sub_u32 s62, s62, 1
    s_cmp_lg_u32 s62, 0
    s_cbranch_scc1 L_wl_18
    s_endpgm
L_wlok_19:
L_vok_16:
    s_bitcmp1_b32 0x1ff0100, s48
    s_cbranch_scc0 L_vnd_17
    v_add_u32 v9, s49, v6
    s_add_u32 s50, s50, 1
    ds_write_b128 v9, v[28:31] offset:0
    ds_write_b128 v9, v[32:35] offset:16
    ds_write_b128 v9, v[36:39] offset:256
    ds_write_b128 v9, v[40:43] offset:272
    ds_write_b128 v9, v[44:47] offset:512
    ds_write_b128 v9, v[48:51] offset:528
    v_mov_b32 v8, s50
    ds_write_b32 v7, v8 offset:0
    s_add_u32 s49, s49, 12288
    s_cmp_eq_u32 s49, 36864
    s_cselect_b32 s49, 0, s49
    v_mov_b32 v28, 0
    v_mov_b32 v29, 0
    v_mov_b32 v30, 0
    v_mov_b32 v31, 0
    v_mov_b32 v32, 0
    v_mov_b32 v33, 0
    v_mov_b32 v34, 0
    v_mov_b32 v35, 0
    v_mov_b32 v36, 0
    v_mov_b32 v37, 0
    v_mov_b32 v38, 0
    v_mov_b32 v39, 0
    v_mov_b32 v40, 0
    v_mov_b32 v41, 0
    v_mov_b32 v42, 0
    v_mov_b32 v43, 0
    v_mov_b32 v44, 0
    v_mov_b32 v45, 0
    v_mov_b32 v46, 0
    v_mov_b32 v47, 0
    v_mov_b32 v48, 0
    v_mov_b32 v49, 0
    v_mov_b32 v50, 0
    v_mov_b32 v51, 0
L_vnd_17:
    v_and_b32 v60, 0xffff, v52
    v_lshlrev_b32 v61, 16, v52
    v_lshrrev_b32 v62, 16, v52
    v_and_b32 v63, 0xffff0000, v52
    v_dot2c_f32_bf16 v28, v64, v60
    v_dot2c_f32_bf16 v29, v64, v61
    v_dot2c_f32_bf16 v30, v65, v60
    v_dot2c_f32_bf16 v31, v65, v61
    v_dot2c_f32_bf16 v32, v66, v60
    v_dot2c_f32_bf16 v33, v66, v61
    v_dot2c_f32_bf16 v34, v67, v60
    v_dot2c_f32_bf16 v35, v67, v61
    v_dot2c_f32_bf16 v36, v68, v60
    v_dot2c_f32_bf16 v37, v68, v61
    v_dot2c_f32_bf16 v38, v69, v60
    v_dot2c_f32_bf16 v39, v69, v61
    v_dot2c_f32_bf16 v40, v70, v60
    v_dot2c_f32_bf16 v41, v70, v61
    v_dot2c_f32_bf16 v42, v71, v60
    v_dot2c_f32_bf16 v43, v71, v61
    v_dot2c_f32_bf16 v44, v72, v60
    v_dot2c_f32_bf16 v45, v72, v61
    v_dot2c_f32_bf16 v46, v73, v60
    v_dot2c_f32_bf16 v47, v73, v61
    v_dot2c_f32_bf16 v48, v74, v60
    v_dot2c_f32_bf16 v49, v74, v61
    v_dot2c_f32_bf16 v50, v75, v60
    v_dot2c_f32_bf16 v51, v75, v61
    s_waitcnt vmcnt(14)
    buffer_load_dwordx4 v[64:67], v3, s[8:11], s44 offen offset:0 nt
    buffer_load_dwordx4 v[68:71], v3, s[8:11], s44 offen offset:128 nt
    buffer_load_dwordx4 v[72:75], v3, s[8:11], s44 offen offset:256 nt
    v_dot2c_f32_bf16 v28, v76, v62
    v_dot2c_f32_bf16 v29, v76, v63
    v_dot2c_f32_bf16 v30, v77, v62
    v_dot2c_f32_bf16 v31, v77, v63
    v_dot2c_f32_bf16 v32, v78, v62
    v_dot2c_f32_bf16 v33, v78, v63
    v_dot2c_f32_bf16 v34, v79, v62
    v_dot2c_f32_bf16 v35, v79, v63
    v_dot2c_f32_bf16 v36, v80, v62
    v_dot2c_f32_bf16 v37, v80, v63
    v_dot2c_f32_bf16 v38, v81, v62
    v_dot2c_f32_bf16 v39, v81, v63
    v_dot2c_f32_bf16 v40, v82, v62
    v_dot2c_f32_bf16 v41, v82, v63
    v_dot2c_f32_bf16 v42, v83, v62
    v_dot2c_f32_bf16 v43, v83, v63
    v_dot2c_f32_bf16 v44, v84, v62
    v_dot2c_f32_bf16 v45, v84, v63
    v_dot2c_f32_bf16 v46, v85, v62
    v_dot2c_f32_bf16 v47, v85, v63
    v_dot2c_f32_bf16 v48, v86, v62
    v_dot2c_f32_bf16 v49, v86, v63
    v_dot2c_f32_bf16 v50, v87, v62
    v_dot2c_f32_bf16 v51, v87, v63
    s_waitcnt vmcnt(14)
    buffer_load_dwordx4 v[76:79], v3, s[8:11], s44 offen offset:3072 nt
    buffer_load_dwordx4 v[80:83], v3, s[8:11], s44 offen offset:3200 nt
    buffer_load_dwordx4 v[84:87], v3, s[8:11], s44 offen offset:3328 nt
    s_add_u32 s44, s44, 393216
    v_and_b32 v60, 0xffff, v53
    v_lshlrev_b32 v61, 16, v53
    v_lshrrev_b32 v62, 16, v53
    v_and_b32 v63, 0xffff0000, v53
    v_dot2c_f32_bf16 v28, v88, v60
    v_dot2c_f32_bf16 v29, v88, v61
    v_dot2c_f32_bf16 v30, v89, v60
    v_dot2c_f32_bf16 v31, v89, v61
    v_dot2c_f32_bf16 v32, v90, v60
    v_dot2c_f32_bf16 v33, v90, v61
    v_dot2c_f32_bf16 v34, v91, v60
    v_dot2c_f32_bf16 v35, v91, v61
    v_dot2c_f32_bf16 v36, v92, v60
    v_dot2c_f32_bf16 v37, v92, v61
    v_dot2c_f32_bf16 v38, v93, v60
    v_dot2c_f32_bf16 v39, v93, v61
    v_dot2c_f32_bf16 v40, v94, v60
    v_dot2c_f32_bf16 v41, v94, v61
    v_dot2c_f32_bf16 v42, v95, v60
    v_dot2c_f32_bf16 v43, v95, v61
    v_dot2c_f32_bf16 v44, v96, v60
    v_dot2c_f32_bf16 v45, v96, v61
    v_dot2c_f32_bf16 v46, v97, v60
    v_dot2c_f32_bf16 v47, v97, v61
    v_dot2c_f32_bf16 v48, v98, v60
    v_dot2c_f32_bf16 v49, v98, v61
    v_dot2c_f32_bf16 v50, v99, v60
    v_dot2c_f32_bf16 v51, v99, v61
    s_waitcnt vmcnt(14)
    buffer_load_dwordx4 v[88:91], v3, s[8:11], s44 offen offset:0 nt
    buffer_load_dwordx4 v[92:95], v3, s[8:11], s44 offen offset:128 nt
    buffer_load_dwordx4 v[96:99], v3, s[8:11], s44 offen offset:256 nt
    v_dot2c_f32_bf16 v28, v100, v62
    v_dot2c_f32_bf16 v29, v100, v63
    v_dot2c_f32_bf16 v30, v101, v62
    v_dot2c_f32_bf16 v31, v101, v63
    v_dot2c_f32_bf16 v32, v102, v62
    v_dot2c_f32_bf16 v33, v102, v63
    v_dot2c_f32_bf16 v34, v103, v62
    v_dot2c_f32_bf16 v35, v103, v63
    v_dot2c_f32_bf16 v36, v104, v62
    v_dot2c_f32_bf16 v37, v104, v63
    v_dot2c_f32_bf16 v38, v105, v62
    v_dot2c_f32_bf16 v39, v105, v63
    v_dot2c_f32_bf16 v40, v106, v62
    v_dot2c_f32_bf16 v41, v106, v63
    v_dot2c_f32_bf16 v42, v107, v62
    v_dot2c_f32_bf16 v43, v107, v63
    v_dot2c_f32_bf16 v44, v108, v62
    v_dot2c_f32_bf16 v45, v108, v63
    v_dot2c_f32_bf16 v46, v109, v62
    v_dot2c_f32_bf16 v47, v109, v63
    v_dot2c_f32_bf16 v48, v110, v62
    v_dot2c_f32_bf16 v49, v110, v63
    v_dot2c_f32_bf16 v50, v111, v62
    v_dot2c_f32_bf16 v51, v111, v63
    s_waitcnt vmcnt(14)
    buffer_load_dwordx4 v[100:103], v3, s[8:11], s44 offen offset:3072 nt
    buffer_load_dwordx4 v[104:107], v3, s[8:11], s44 offen offset:3200 nt
    buffer_load_dwordx4 v[108:111], v3, s[8:11], s44 offen offset:3328 nt
    s_add_u32 s44, s44, 393216
    v_and_b32 v60, 0xffff, v54
    v_lshlrev_b32 v61, 16, v54
    v_lshrrev_b32 v62, 16, v54
    v_and_b32 v63, 0xffff0000, v54
    v_dot2c_f32_bf16 v28, v112, v60
    v_dot2c_f32_bf16 v29, v112, v61
    v_dot2c_f32_bf16 v30, v113, v60
    v_dot2c_f32_bf16 v31, v113, v61
    v_dot2c_f32_bf16 v32, v114, v60
    v_dot2c_f32_bf16 v33, v114, v61
    v_dot2c_f32_bf16 v34, v115, v60
    v_dot2c_f32_bf16 v35, v115, v61
    v_dot2c_f32_bf16 v36, v116, v60
    v_dot2c_f32_bf16 v37, v116, v61
    v_dot2c_f32_bf16 v38, v117, v60
    v_dot2c_f32_bf16 v39, v117, v61
    v_dot2c_f32_bf16 v40, v118, v60
    v_dot2c_f32_bf16 v41, v118, v61
    v_dot2c_f32_bf16 v42, v119, v60
    v_dot2c_f32_bf16 v43, v119, v61
    v_dot2c_f32_bf16 v44, v120, v60
    v_dot2c_f32_bf16 v45, v120, v61
    v_dot2c_f32_bf16 v46, v121, v60
    v_dot2c_f32_bf16 v47, v121, v61
    v_dot2c_f32_bf16 v48, v122, v60
    v_dot2c_f32_bf16 v49, v122, v61
    v_dot2c_f32_bf16 v50, v123, v60
    v_dot2c_f32_bf16 v51, v123, v61
    s_waitcnt vmcnt(14)
    buffer_load_dwordx4 v[112:115], v3, s[8:11], s44 offen offset:0 nt
    buffer_load_dwordx4 v[116:119], v3, s[8:11], s44 offen offset:128 nt
    buffer_load_dwordx4 v[120:123], v3, s[8:11], s44 offen offset:256 nt
    v_dot2c_f32_bf16 v28, v124, v62
    v_dot2c_f32_bf16 v29, v124, v63
    v_dot2c_f32_bf16 v30, v125, v62
    v_dot2c_f32_bf16 v31, v125, v63
    v_dot2c_f32_bf16 v32, v126, v62
    v_dot2c_f32_bf16 v33, v126, v63
    v_dot2c_f32_bf16 v34, v127, v62
    v_dot2c_f32_bf16 v35, v127, v63
    v_dot2c_f32_bf16 v36, v128, v62
    v_dot2c_f32_bf16 v37, v128, v63
    v_dot2c_f32_bf16 v38, v129, v62
    v_dot2c_f32_bf16 v39, v129, v63
    v_dot2c_f32_bf16 v40, v130, v62
    v_dot2c_f32_bf16 v41, v130, v63
    v_dot2c_f32_bf16 v42, v131, v62
    v_dot2c_f32_bf16 v43, v131, v63
    s_waitcnt vmcnt(15)
    v_readlane_b32 s93, v56, 63
    v_dot2c_f32_bf16 v44, v132, v62
    v_dot2c_f32_bf16 v45, v132, v63
    v_dot2c_f32_bf16 v46, v133, v62
    v_dot2c_f32_bf16 v47, v133, v63
    v_dot2c_f32_bf16 v48, v134, v62
    v_dot2c_f32_bf16 v49, v134, v63
    v_dot2c_f32_bf16 v50, v135, v62
    v_dot2c_f32_bf16 v51, v135, v63
    v_sub_u32 v56, v56, v57
    s_waitcnt vmcnt(12)
    buffer_load_dwordx4 v[124:127], v3, s[8:11], s44 offen offset:3072 nt
    buffer_load_dwordx4 v[128:131], v3, s[8:11], s44 offen offset:3200 nt
    buffer_load_dwordx4 v[132:135], v3, s[8:11], s44 offen offset:3328 nt
    s_add_u32 s44, s44, 393216
    v_add_u32 v57, 8, v56
    v_and_b32 v60, 0xffff, v55
    v_lshlrev_b32 v61, 16, v55
    v_lshrrev_b32 v62, 16, v55
    v_and_b32 v63, 0xffff0000, v55
    v_add_u32 v13, 1, v13
    ds_write_b32 v7, v13 offset:8
    ds_read_b32 v15, v12 offset:52
    ds_read_b128 v[52:55], v4 offset:0
    v_add_u32 v4, 256, v4
    v_dot2c_f32_bf16 v28, v136, v60
    v_dot2c_f32_bf16 v29, v136, v61
    v_dot2c_f32_bf16 v30, v137, v60
    v_dot2c_f32_bf16 v31, v137, v61
    v_dot2c_f32_bf16 v32, v138, v60
    v_dot2c_f32_bf16 v33, v138, v61
    v_dot2c_f32_bf16 v34, v139, v60
    v_dot2c_f32_bf16 v35, v139, v61
    v_cmp_gt_u32 vcc, 17, v57
    s_nop 1
    v_lshl_add_u32 v56, v56, 1, 1
    v_dot2c_f32_bf16 v36, v140, v60
    v_dot2c_f32_bf16 v37, v140, v61
    v_dot2c_f32_bf16 v38, v141, v60
    v_dot2c_f32_bf16 v39, v141, v61
    v_dot2c_f32_bf16 v40, v142, v60
    v_dot2c_f32_bf16 v41, v142, v61
    v_dot2c_f32_bf16 v42, v143, v60
    v_dot2c_f32_bf16 v43, v143, v61
    v_cndmask_b32 v56, 0, v56, vcc
    s_nop 1
    v_add_u32_dpp v56, v56, v56 quad_perm:[1,0,3,2] row_mask:0xf bank_mask:0xf
    v_dot2c_f32_bf16 v44, v144, v60
    v_dot2c_f32_bf16 v45, v144, v61
    v_dot2c_f32_bf16 v46, v145, v60
    v_dot2c_f32_bf16 v47, v145, v61
    v_dot2c_f32_bf16 v48, v146, v60
    v_dot2c_f32_bf16 v49, v146, v61
    v_dot2c_f32_bf16 v50, v147, v60
    v_dot2c_f32_bf16 v51, v147, v61
    v_add_u32_dpp v56, v56, v56 quad_perm:[2,3,0,1] row_mask:0xf bank_mask:0xf
    s_waitcnt vmcnt(12)
    buffer_load_dwordx4 v[136:139], v3, s[8:11], s44 offen offset:0 nt
    buffer_load_dwordx4 v[140:143], v3, s[8:11], s44 offen offset:128 nt
    buffer_load_dwordx4 v[144:147], v3, s[8:11], s44 offen offset:256 nt
    v_add_u32_dpp v56, v56, v56 row_half_mirror row_mask:0xf bank_mask:0xf
    v_dot2c_f32_bf16 v28, v148, v62
    v_dot2c_f32_bf16 v29, v148, v63
    v_dot2c_f32_bf16 v30, v149, v62
    v_dot2c_f32_bf16 v31, v149, v63
    v_dot2c_f32_bf16 v32, v150, v62
    v_dot2c_f32_bf16 v33, v150, v63
    v_dot2c_f32_bf16 v34, v151, v62
    v_dot2c_f32_bf16 v35, v151, v63
    v_add_u32_dpp v56, v56, v56 row_mirror row_mask:0xf bank_mask:0xf
    s_nop 1
    v_readlane_b32 s88, v56, 0
    v_dot2c_f32_bf16 v36, v152, v62
    v_dot2c_f32_bf16 v37, v152, v63
    v_dot2c_f32_bf16 v38, v153, v62
    v_dot2c_f32_bf16 v39, v153, v63
    v_dot2c_f32_bf16 v40, v154, v62
    v_dot2c_f32_bf16 v41, v154, v63
    v_dot2c_f32_bf16 v42, v155, v62
    v_dot2c_f32_bf16 v43, v155, v63
    v_readlane_b32 s89, v56, 16
    s_nop 1
    v_readlane_b32 s90, v56, 32
    v_dot2c_f32_bf16 v44, v156, v62
    v_dot2c_f32_bf16 v45, v156, v63
    v_dot2c_f32_bf16 v46, v157, v62
    v_dot2c_f32_bf16 v47, v157, v63
    v_dot2c_f32_bf16 v48, v158, v62
    v_dot2c_f32_bf16 v49, v158, v63
    v_dot2c_f32_bf16 v50, v159, v62
    v_dot2c_f32_bf16 v51, v159, v63
    v_readlane_b32 s91, v56, 48
    s_branch L_vb_end
L_vb1:
    s_waitcnt vmcnt(9)
    buffer_load_dwordx4 v[148:151], v3, s[8:11], s44 offen offset:3072 nt
    buffer_load_dwordx4 v[152:155], v3, s[8:11], s44 offen offset:3200 nt
    buffer_load_dwordx4 v[156:159], v3, s[8:11], s44 offen offset:3328 nt
    s_bitcmp1_b32 0x7f0000, s48
    s_cselect_b32 s45, s46, 393216
    s_cmp_eq_u32 s48, 7
    s_cselect_b32 s45, s47, s45
    s_cmp_eq_u32 s48, 15
    s_cselect_b32 s45, s42, s45
    s_cmp_eq_u32 s48, 23
    s_cselect_b32 s45, s43, s45
    s_add_u32 s44, s44, s45
    v_add_u32 v57, s60, v13
    buffer_store_dword v57, v58, s[12:15], s58 offen
    buffer_load_dword v56, v59, s[12:15], s59 offen sc1
    s_waitcnt lgkmcnt(0)
    v_readfirstlane_b32 s63, v15
    s_cmp_ge_u32 s63, s52
    s_cbranch_scc1 L_vok_20
    s_mov_b32 s62, 4000000
    v_mov_b32 v12, 0
L_wl_22:
    ds_read_b32 v8, v12 offset:52
    s_waitcnt lgkmcnt(0)
    s_nop 0
    v_readfirstlane_b32 s63, v8
    s_cmp_ge_u32 s63, s52
    s_cbranch_scc1 L_wlok_23
    s_sub_u32 s62, s62, 1
    s_cmp_lg_u32 s62, 0
    s_cbranch_scc1 L_wl_22
    s_endpgm
L_wlok_23:
L_vok_20:
    s_bitcmp1_b32 0x1ff0100, s48
    s_cbranch_scc0 L_vnd_21
    v_add_u32 v9, s49, v6
    s_add_u32 s50, s50, 1
    ds_write_b128 v9, v[28:31] offset:0
    ds_write_b128 v9, v[32:35] offset:16
    ds_write_b128 v9, v[36:39] offset:256
    ds_write_b128 v9, v[40:43] offset:272
    ds_write_b128 v9, v[44:47] offset:512
    ds_write_b128 v9, v[48:51] offset:528
    v_mov_b32 v8, s50
    ds_write_b32 v7, v8 offset:0
    s_add_u32 s49, s49, 12288
    s_cmp_eq_u32 s49, 36864
    s_cselect_b32 s49, 0, s49
    v_mov_b32 v28, 0
    v_mov_b32 v29, 0
    v_mov_b32 v30, 0
    v_mov_b32 v31, 0
    v_mov_b32 v32, 0
    v_mov_b32 v33, 0
    v_mov_b32 v34, 0
    v_mov_b32 v35, 0
    v_mov_b32 v36, 0
    v_mov_b32 v37, 0
    v_mov_b32 v38, 0
    v_mov_b32 v39, 0
    v_mov_b32 v40, 0
    v_mov_b32 v41, 0
    v_mov_b32 v42, 0
    v_mov_b32 v43, 0
    v_mov_b32 v44, 0
    v_mov_b32 v45, 0
    v_mov_b32 v46, 0
    v_mov_b32 v47, 0
    v_mov_b32 v48, 0
    v_mov_b32 v49, 0
    v_mov_b32 v50, 0
    v_mov_b32 v51, 0
L_vnd_21:
    v_and_b32 v60, 0xffff, v52
    v_lshlrev_b32 v61, 16, v52
    v_lshrrev_b32 v62, 16, v52
    v_and_b32 v63, 0xffff0000, v52
    v_dot2c_f32_bf16 v28, v64, v60
    v_dot2c_f32_bf16 v29, v64, v61
    v_dot2c_f32_bf16 v30, v65, v60
    v_dot2c_f32_bf16 v31, v65, v61
    v_dot2c_f32_bf16 v32, v66, v60
    v_dot2c_f32_bf16 v33, v66, v61
    v_dot2c_f32_bf16 v34, v67, v60
    v_dot2c_f32_bf16 v35, v67, v61
    v_dot2c_f32_bf16 v36, v68, v60
    v_dot2c_f32_bf16 v37, v68, v61
    v_dot2c_f32_bf16 v38, v69, v60
    v_dot2c_f32_bf16 v39, v69, v61
    v_dot2c_f32_bf16 v40, v70, v60
    v_dot2c_f32_bf16 v41, v70, v61
    v_dot2c_f32_bf16 v42, v71, v60
    v_dot2c_f32_bf16 v43, v71, v61
    v_dot2c_f32_bf16 v44, v72, v60
    v_dot2c_f32_bf16 v45, v72, v61
    v_dot2c_f32_bf16 v46, v73, v60
    v_dot2c_f32_bf16 v47, v73, v61
    v_dot2c_f32_bf16 v48, v74, v60
    v_dot2c_f32_bf16 v49, v74, v61
    v_dot2c_f32_bf16 v50, v75, v60
    v_dot2c_f32_bf16 v51, v75, v61
    s_waitcnt vmcnt(11)
    buffer_load_dwordx4 v[64:67], v3, s[8:11], s44 offen offset:0 nt
    buffer_load_dwordx4 v[68:71], v3, s[8:11], s44 offen offset:128 nt
    buffer_load_dwordx4 v[72:75], v3, s[8:11], s44 offen offset:256 nt
    v_dot2c_f32_bf16 v28, v76, v62
    v_dot2c_f32_bf16 v29, v76, v63
    v_dot2c_f32_bf16 v30, v77, v62
    v_dot2c_f32_bf16 v31, v77, v63
    v_dot2c_f32_bf16 v32, v78, v62
    v_dot2c_f32_bf16 v33, v78, v63
    v_dot2c_f32_bf16 v34, v79, v62
    v_dot2c_f32_bf16 v35, v79, v63
    v_dot2c_f32_bf16 v36, v80, v62
    v_dot2c_f32_bf16 v37, v80, v63
    v_dot2c_f32_bf16 v38, v81, v62
    v_dot2c_f32_bf16 v39, v81, v63
    v_dot2c_f32_bf16 v40, v82, v62
    v_dot2c_f32_bf16 v41, v82, v63
    v_dot2c_f32_bf16 v42, v83, v62
    v_dot2c_f32_bf16 v43, v83, v63
    v_dot2c_f32_bf16 v44, v84, v62
    v_dot2c_f32_bf16 v45, v84, v63
    v_dot2c_f32_bf16 v46, v85, v62
    v_dot2c_f32_bf16 v47, v85, v63
    v_dot2c_f32_bf16 v48, v86, v62
    v_dot2c_f32_bf16 v49, v86, v63
    v_dot2c_f32_bf16 v50, v87, v62
    v_dot2c_f32_bf16 v51, v87, v63
    s_waitcnt vmcnt(11)
    buffer_load_dwordx4 v[76:79], v3, s[8:11], s44 offen offset:3072 nt
    buffer_load_dwordx4 v[80:83], v3, s[8:11], s44 offen offset:3200 nt
    buffer_load_dwordx4 v[84:87], v3, s[8:11], s44 offen offset:3328 nt
    s_add_u32 s44, s44, 393216
    v_and_b32 v60, 0xffff, v53
    v_lshlrev_b32 v61, 16, v53
    v_lshrrev_b32 v62, 16, v53
    v_and_b32 v63, 0xffff0000, v53
    v_dot2c_f32_bf16 v28, v88, v60
    v_dot2c_f32_bf16 v29, v88, v61
    v_dot2c_f32_bf16 v30, v89, v60
    v_dot2c_f32_bf16 v31, v89, v61
    v_dot2c_f32_bf16 v32, v90, v60
    v_dot2c_f32_bf16 v33, v90, v61
    v_dot2c_f32_bf16 v34, v91, v60
    v_dot2c_f32_bf16 v35, v91, v61
    v_dot2c_f32_bf16 v36, v92, v60
    v_dot2c_f32_bf16 v37, v92, v61
    v_dot2c_f32_bf16 v38, v93, v60
    v_dot2c_f32_bf16 v39, v93, v61
    v_dot2c_f32_bf16 v40, v94, v60
    v_dot2c_f32_bf16 v41, v94, v61
    v_dot2c_f32_bf16 v42, v95, v60
    v_dot2c_f32_bf16 v43, v95, v61
    v_dot2c_f32_bf16 v44, v96, v60
    v_dot2c_f32_bf16 v45, v96, v61
    v_dot2c_f32_bf16 v46, v97, v60
    v_dot2c_f32_bf16 v47, v97, v61
    v_dot2c_f32_bf16 v48, v98, v60
    v_dot2c_f32_bf16 v49, v98, v61
    v_dot2c_f32_bf16 v50, v99, v60
    v_dot2c_f32_bf16 v51, v99, v61
    s_waitcnt vmcnt(11)
    buffer_load_dwordx4 v[88:91], v3, s[8:11], s44 offen offset:0 nt
    buffer_load_dwordx4 v[92:95], v3, s[8:11], s44 offen offset:128 nt
    buffer_load_dwordx4 v[96:99], v3, s[8:11], s44 offen offset:256 nt
    v_dot2c_f32_bf16 v28, v100, v62
    v_dot2c_f32_bf16 v29, v100, v63
    v_dot2c_f32_bf16 v30, v101, v62
    v_dot2c_f32_bf16 v31, v101, v63
    v_dot2c_f32_bf16 v32, v102, v62
    v_dot2c_f32_bf16 v33, v102, v63
    v_dot2c_f32_bf16 v34, v103, v62
    v_dot2c_f32_bf16 v35, v103, v63
    v_dot2c_f32_bf16 v36, v104, v62
    v_dot2c_f32_bf16 v37, v104, v63
    v_dot2c_f32_bf16 v38, v105, v62
    v_dot2c_f32_bf16 v39, v105, v63
    v_dot2c_f32_bf16 v40, v106, v62
    v_dot2c_f32_bf16 v41, v106, v63
    v_dot2c_f32_bf16 v42, v107, v62
    v_dot2c_f32_bf16 v43, v107, v63
    v_dot2c_f32_bf16 v44, v108, v62
    v_dot2c_f32_bf16 v45, v108, v63
    v_dot2c_f32_bf16 v46, v109, v62
    v_dot2c_f32_bf16 v47, v109, v63
    v_dot2c_f32_bf16 v48, v110, v62
    v_dot2c_f32_bf16 v49, v110, v63
    v_dot2c_f32_bf16 v50, v111, v62
    v_dot2c_f32_bf16 v51, v111, v63
    s_waitcnt vmcnt(11)
    buffer_load_dwordx4 v[100:103], v3, s[8:11], s44 offen offset:3072 nt
    buffer_load_dwordx4 v[104:107], v3, s[8:11], s44 offen offset:3200 nt
    buffer_load_dwordx4 v[108:111], v3, s[8:11], s44 offen offset:3328 nt
    s_add_u32 s44, s44, 393216
    v_and_b32 v60, 0xffff, v54
    v_lshlrev_b32 v61, 16, v54
    v_lshrrev_b32 v62, 16, v54
    v_and_b32 v63, 0xffff0000, v54
    v_dot2c_f32_bf16 v28, v112, v60
    v_dot2c_f32_bf16 v29, v112, v61
    v_dot2c_f32_bf16 v30, v113, v60
    v_dot2c_f32_bf16 v31, v113, v61
    v_dot2c_f32_bf16 v32, v114, v60
    v_dot2c_f32_bf16 v33, v114, v61
    v_dot2c_f32_bf16 v34, v115, v60
    v_dot2c_f32_bf16 v35, v115, v61
    v_dot2c_f32_bf16 v36, v116, v60
    v_dot2c_f32_bf16 v37, v116, v61
    v_dot2c_f32_bf16 v38, v117, v60
    v_dot2c_f32_bf16 v39, v117, v61
    v_dot2c_f32_bf16 v40, v118, v60
    v_dot2c_f32_bf16 v41, v118, v61
    v_dot2c_f32_bf16 v42, v119, v60
    v_dot2c_f32_bf16 v43, v119, v61
    v_dot2c_f32_bf16 v44, v120, v60
    v_dot2c_f32_bf16 v45, v120, v61
    v_dot2c_f32_bf16 v46, v121, v60
    v_dot2c_f32_bf16 v47, v121, v61
    v_dot2c_f32_bf16 v48, v122, v60
    v_dot2c_f32_bf16 v49, v122, v61
    v_dot2c_f32_bf16 v50, v123, v60
    v_dot2c_f32_bf16 v51, v123, v61
    s_waitcnt vmcnt(9)
    buffer_load_dwordx4 v[112:115], v3, s[8:11], s44 offen offset:0 nt
    buffer_load_dwordx4 v[116:119], v3, s[8:11], s44 offen offset:128 nt
    buffer_load_dwordx4 v[120:123], v3, s[8:11], s44 offen offset:256 nt
    v_dot2c_f32_bf16 v28, v124, v62
    v_dot2c_f32_bf16 v29, v124, v63
    v_dot2c_f32_bf16 v30, v125, v62
    v_dot2c_f32_bf16 v31, v125, v63
    v_dot2c_f32_bf16 v32, v126, v62
    v_dot2c_f32_bf16 v33, v126, v63
    v_dot2c_f32_bf16 v34, v127, v62
    v_dot2c_f32_bf16 v35, v127, v63
    v_dot2c_f32_bf16 v36, v128, v62
    v_dot2c_f32_bf16 v37, v128, v63
    v_dot2c_f32_bf16 v38, v129, v62
    v_dot2c_f32_bf16 v39, v129, v63
    v_dot2c_f32_bf16 v40, v130, v62
    v_dot2c_f32_bf16 v41, v130, v63
    v_dot2c_f32_bf16 v42, v131, v62
    v_dot2c_f32_bf16 v43, v131, v63
    s_waitcnt vmcnt(15)
    v_readlane_b32 s93, v56, 63
    v_dot2c_f32_bf16 v44, v132, v62
    v_dot2c_f32_bf16 v45, v132, v63
    v_dot2c_f32_bf16 v46, v133, v62
    v_dot2c_f32_bf16 v47, v133, v63
    v_dot2c_f32_bf16 v48, v134, v62
    v_dot2c_f32_bf16 v49, v134, v63
    v_dot2c_f32_bf16 v50, v135, v62
    v_dot2c_f32_bf16 v51, v135, v63
    v_sub_u32 v56, v56, v57
    s_waitcnt vmcnt(9)
    buffer_load_dwordx4 v[124:127], v3, s[8:11], s44 offen offset:3072 nt
    buffer_load_dwordx4 v[128:131], v3, s[8:11], s44 offen offset:3200 nt
    buffer_load_dwordx4 v[132:135], v3, s[8:11], s44 offen offset:3328 nt
    s_add_u32 s44, s44, 393216
    v_add_u32 v57, 8, v56
    v_and_b32 v60, 0xffff, v55
    v_lshlrev_b32 v61, 16, v55
    v_lshrrev_b32 v62, 16, v55
    v_and_b32 v63, 0xffff0000, v55
    v_add_u32 v13, 1, v13
    ds_write_b32 v7, v13 offset:8
    ds_read_b32 v15, v12 offset:52
    ds_read_b128 v[52:55], v4 offset:0
    v_add_u32 v4, 256, v4
    v_dot2c_f32_bf16 v28, v136, v60
    v_dot2c_f32_bf16 v29, v136, v61
    v_dot2c_f32_bf16 v30, v137, v60
    v_dot2c_f32_bf16 v31, v137, v61
    v_dot2c_f32_bf16 v32, v138, v60
    v_dot2c_f32_bf16 v33, v138, v61
    v_dot2c_f32_bf16 v34, v139, v60
    v_dot2c_f32_bf16 v35, v139, v61
    v_cmp_gt_u32 vcc, 17, v57
    s_nop 1
    v_lshl_add_u32 v56, v56, 1, 1
    v_dot2c_f32_bf16 v36, v140, v60
    v_dot2c_f32_bf16 v37, v140, v61
    v_dot2c_f32_bf16 v38, v141, v60
    v_dot2c_f32_bf16 v39, v141, v61
    v_dot2c_f32_bf16 v40, v142, v60
    v_dot2c_f32_bf16 v41, v142, v61
    v_dot2c_f32_bf16 v42, v143, v60
    v_dot2c_f32_bf16 v43, v143, v61
    v_cndmask_b32 v56, 0, v56, vcc
    s_nop 1
    v_add_u32_dpp v56, v56, v56 quad_perm:[1,0,3,2] row_mask:0xf bank_mask:0xf
    v_dot2c_f32_bf16 v44, v144, v60
    v_dot2c_f32_bf16 v45, v144, v61
    v_dot2c_f32_bf16 v46, v145, v60
    v_dot2c_f32_bf16 v47, v145, v61
    v_dot2c_f32_bf16 v48, v146, v60
    v_dot2c_f32_bf16 v49, v146, v61
    v_dot2c_f32_bf16 v50, v147, v60
    v_dot2c_f32_bf16 v51, v147, v61
    v_add_u32_dpp v56, v56, v56 quad_perm:[2,3,0,1] row_mask:0xf bank_mask:0xf
    s_waitcnt vmcnt(9)
    buffer_load_dwordx4 v[136:139], v3, s[8:11], s44 offen offset:0 nt
    buffer_load_dwordx4 v[140:143], v3, s[8:11], s44 offen offset:128 nt
    buffer_load_dwordx4 v[144:147], v3, s[8:11], s44 offen offset:256 nt
    v_add_u32_dpp v56, v56, v56 row_half_mirror row_mask:0xf bank_mask:0xf
    v_dot2c_f32_bf16 v28, v148, v62
    v_dot2c_f32_bf16 v29, v148, v63
    v_dot2c_f32_bf16 v30, v149, v62
    v_dot2c_f32_bf16 v31, v149, v63
    v_dot2c_f32_bf16 v32, v150, v62
    v_dot2c_f32_bf16 v33, v150, v63
    v_dot2c_f32_bf16 v34, v151, v62
    v_dot2c_f32_bf16 v35, v151, v63
    v_add_u32_dpp v56, v56, v56 row_mirror row_mask:0xf bank_mask:0xf
    s_nop 1
    v_readlane_b32 s88, v56, 0
    v_dot2c_f32_bf16 v36, v152, v62
    v_dot2c_f32_bf16 v37, v152, v63
    v_dot2c_f32_bf16 v38, v153, v62
    v_dot2c_f32_bf16 v39, v153, v63
    v_dot2c_f32_bf16 v40, v154, v62
    v_dot2c_f32_bf16 v41, v154, v63
    v_dot2c_f32_bf16 v42, v155, v62
    v_dot2c_f32_bf16 v43, v155, v63
    v_readlane_b32 s89, v56, 16
    s_nop 1
    v_readlane_b32 s90, v56, 32
    v_dot2c_f32_bf16 v44, v156, v62
    v_dot2c_f32_bf16 v45, v156, v63
    v_dot2c_f32_bf16 v46, v157, v62
    v_dot2c_f32_bf16 v47, v157, v63
    v_dot2c_f32_bf16 v48, v158, v62
    v_dot2c_f32_bf16 v49, v158, v63
    v_dot2c_f32_bf16 v50, v159, v62
    v_dot2c_f32_bf16 v51, v159, v63
    v_readlane_b32 s91, v56, 48
L_vb_end:
    s_add_u32 s88, s88, s89
    s_add_u32 s90, s90, s91
    s_add_u32 s88, s88, s90
    s_sub_u32 s93, s93, s55
    s_sub_u32 s89, s93, 128
    s_cmp_lt_u32 s93, 256
    s_cselect_b32 s89, s89, 0
    s_add_u32 s88, s88, s89
    s_mov_b32 s53, 1
    s_cmp_gt_i32 s88, 45
    s_cselect_b32 s53, 2, s53
    s_cmp_lt_i32 s88, -45
    s_cselect_b32 s53, 0, s53
L_nolevel_24:
    s_add_u32 s48, s48, 1
    s_cmp_ge_u32 s48, 10
    s_cselect_b32 s6, 1, 0
    s_sub_i32 s52, s48, 17
    s_max_i32 s52, s52, s6
    s_min_i32 s52, s52, 7
    s_cmp_lt_u32 s48, 31
    s_cbranch_scc1 L_vloop
    v_readfirstlane_b32 s54, v14
    s_waitcnt vmcnt(18)
    buffer_load_dwordx4 v[148:151], v3, s[8:11], s44 offen offset:3072 nt
    buffer_load_dwordx4 v[152:155], v3, s[8:11], s44 offen offset:3200 nt
    buffer_load_dwordx4 v[156:159], v3, s[8:11], s44 offen offset:3328 nt
    s_add_u32 s44, s44, 393216
    s_waitcnt lgkmcnt(0)
    v_mov_b32 v13, 64
    ds_write_b32 v7, v13 offset:8
    v_and_b32 v60, 0xffff, v52
    v_lshlrev_b32 v61, 16, v52
    v_lshrrev_b32 v62, 16, v52
    v_and_b32 v63, 0xffff0000, v52
    v_dot2c_f32_bf16 v28, v64, v60
    v_dot2c_f32_bf16 v29, v64, v61
    v_dot2c_f32_bf16 v30, v65, v60
    v_dot2c_f32_bf16 v31, v65, v61
    v_dot2c_f32_bf16 v32, v66, v60
    v_dot2c_f32_bf16 v33, v66, v61
    v_dot2c_f32_bf16 v34, v67, v60
    v_dot2c_f32_bf16 v35, v67, v61
    v_dot2c_f32_bf16 v36, v68, v60
    v_dot2c_f32_bf16 v37, v68, v61
    v_dot2c_f32_bf16 v38, v69, v60
    v_dot2c_f32_bf16 v39, v69, v61
    v_dot2c_f32_bf16 v40, v70, v60
    v_dot2c_f32_bf16 v41, v70, v61
    v_dot2c_f32_bf16 v42, v71, v60
    v_dot2c_f32_bf16 v43, v71, v61
    v_dot2c_f32_bf16 v44, v72, v60
    v_dot2c_f32_bf16 v45, v72, v61
    v_dot2c_f32_bf16 v46, v73, v60
    v_dot2c_f32_bf16 v47, v73, v61
    v_dot2c_f32_bf16 v48, v74, v60
    v_dot2c_f32_bf16 v49, v74, v61
    v_dot2c_f32_bf16 v50, v75, v60
    v_dot2c_f32_bf16 v51, v75, v61
    s_waitcnt vmcnt(20)
    v_dot2c_f32_bf16 v28, v76, v62
    v_dot2c_f32_bf16 v29, v76, v63
    v_dot2c_f32_bf16 v30, v77, v62
    v_dot2c_f32_bf16 v31, v77, v63
    v_dot2c_f32_bf16 v32, v78, v62
    v_dot2c_f32_bf16 v33, v78, v63
    v_dot2c_f32_bf16 v34, v79, v62
    v_dot2c_f32_bf16 v35, v79, v63
    s_waitcnt vmcnt(19)
    v_dot2c_f32_bf16 v36, v80, v62
    v_dot2c_f32_bf16 v37, v80, v63
    v_dot2c_f32_bf16 v38, v81, v62
    v_dot2c_f32_bf16 v39, v81, v63
    v_dot2c_f32_bf16 v40, v82, v62
    v_dot2c_f32_bf16 v41, v82, v63
    v_dot2c_f32_bf16 v42, v83, v62
    v_dot2c_f32_bf16 v43, v83, v63
    s_waitcnt vmcnt(18)
    v_dot2c_f32_bf16 v44, v84, v62
    v_dot2c_f32_bf16 v45, v84, v63
    v_dot2c_f32_bf16 v46, v85, v62
    v_dot2c_f32_bf16 v47, v85, v63
    v_dot2c_f32_bf16 v48, v86, v62
    v_dot2c_f32_bf16 v49, v86, v63
    v_dot2c_f32_bf16 v50, v87, v62
    v_dot2c_f32_bf16 v51, v87, v63
    s_waitcnt vmcnt(17)
    v_and_b32 v60, 0xffff, v53
    v_lshlrev_b32 v61, 16, v53
    v_lshrrev_b32 v62, 16, v53
    v_and_b32 v63, 0xffff0000, v53
    v_dot2c_f32_bf16 v28, v88, v60
    v_dot2c_f32_bf16 v29, v88, v61
    v_dot2c_f32_bf16 v30, v89, v60
    v_dot2c_f32_bf16 v31, v89, v61
    v_dot2c_f32_bf16 v32, v90, v60
    v_dot2c_f32_bf16 v33, v90, v61
    v_dot2c_f32_bf16 v34, v91, v60
    v_dot2c_f32_bf16 v35, v91, v61
    s_waitcnt vmcnt(16)
    v_dot2c_f32_bf16 v36, v92, v60
    v_dot2c_f32_bf16 v37, v92, v61
    v_dot2c_f32_bf16 v38, v93, v60
    v_dot2c_f32_bf16 v39, v93, v61
    v_dot2c_f32_bf16 v40, v94, v60
    v_dot2c_f32_bf16 v41, v94, v61
    v_dot2c_f32_bf16 v42, v95, v60
    v_dot2c_f32_bf16 v43, v95, v61
    s_waitcnt vmcnt(15)
    v_dot2c_f32_bf16 v44, v96, v60
    v_dot2c_f32_bf16 v45, v96, v61
    v_dot2c_f32_bf16 v46, v97, v60
    v_dot2c_f32_bf16 v47, v97, v61
    v_dot2c_f32_bf16 v48, v98, v60
    v_dot2c_f32_bf16 v49, v98, v61
    v_dot2c_f32_bf16 v50, v99, v60
    v_dot2c_f32_bf16 v51, v99, v61
    s_waitcnt vmcnt(14)
    v_dot2c_f32_bf16 v28, v100, v62
    v_dot2c_f32_bf16 v29, v100, v63
    v_dot2c_f32_bf16 v30, v101, v62
    v_dot2c_f32_bf16 v31, v101, v63
    v_dot2c_f32_bf16 v32, v102, v62
    v_dot2c_f32_bf16 v33, v102, v63
    v_dot2c_f32_bf16 v34, v103, v62
    v_dot2c_f32_bf16 v35, v103, v63
    s_waitcnt vmcnt(13)
    v_dot2c_f32_bf16 v36, v104, v62
    v_dot2c_f32_bf16 v37, v104, v63
    v_dot2c_f32_bf16 v38, v105, v62
    v_dot2c_f32_bf16 v39, v105, v63
    v_dot2c_f32_bf16 v40, v106, v62
    v_dot2c_f32_bf16 v41, v106, v63
    v_dot2c_f32_bf16 v42, v107, v62
    v_dot2c_f32_bf16 v43, v107, v63
    s_waitcnt vmcnt(12)
    v_dot2c_f32_bf16 v44, v108, v62
    v_dot2c_f32_bf16 v45, v108, v63
    v_dot2c_f32_bf16 v46, v109, v62
    v_dot2c_f32_bf16 v47, v109, v63
    v_dot2c_f32_bf16 v48, v110, v62
    v_dot2c_f32_bf16 v49, v110, v63
    v_dot2c_f32_bf16 v50, v111, v62
    v_dot2c_f32_bf16 v51, v111, v63
    s_waitcnt vmcnt(11)
    v_and_b32 v60, 0xffff, v54
    v_lshlrev_b32 v61, 16, v54
    v_lshrrev_b32 v62, 16, v54
    v_and_b32 v63, 0xffff0000, v54
    v_dot2c_f32_bf16 v28, v112, v60
    v_dot2c_f32_bf16 v29, v112, v61
    v_dot2c_f32_bf16 v30, v113, v60
    v_dot2c_f32_bf16 v31, v113, v61
    v_dot2c_f32_bf16 v32, v114, v60
    v_dot2c_f32_bf16 v33, v114, v61
    v_dot2c_f32_bf16 v34, v115, v60
    v_dot2c_f32_bf16 v35, v115, v61
    s_waitcnt vmcnt(10)
    v_dot2c_f32_bf16 v36, v116, v60
    v_dot2c_f32_bf16 v37, v116, v61
    v_dot2c_f32_bf16 v38, v117, v60
    v_dot2c_f32_bf16 v39, v117, v61
    v_dot2c_f32_bf16 v40, v118, v60
    v_dot2c_f32_bf16 v41, v118, v61
    v_dot2c_f32_bf16 v42, v119, v60
    v_dot2c_f32_bf16 v43, v119, v61
    s_waitcnt vmcnt(9)
    v_dot2c_f32_bf16 v44, v120, v60
    v_dot2c_f32_bf16 v45, v120, v61
    v_dot2c_f32_bf16 v46, v121, v60
    v_dot2c_f32_bf16 v47, v121, v61
    v_dot2c_f32_bf16 v48, v122, v60
    v_dot2c_f32_bf16 v49, v122, v61
    v_dot2c_f32_bf16 v50, v123, v60
    v_dot2c_f32_bf16 v51, v123, v61
    s_waitcnt vmcnt(8)
    v_dot2c_f32_bf16 v28, v124, v62
    v_dot2c_f32_bf16 v29, v124, v63
    v_dot2c_f32_bf16 v30, v125, v62
    v_dot2c_f32_bf16 v31, v125, v63
    v_dot2c_f32_bf16 v32, v126, v62
    v_dot2c_f32_bf16 v33, v126, v63
    v_dot2c_f32_bf16 v34, v127, v62
    v_dot2c_f32_bf16 v35, v127, v63
    s_waitcnt vmcnt(7)
    v_dot2c_f32_bf16 v36, v128, v62
    v_dot2c_f32_bf16 v37, v128, v63
    v_dot2c_f32_bf16 v38, v129, v62
    v_dot2c_f32_bf16 v39, v129, v63
    v_dot2c_f32_bf16 v40, v130, v62
    v_dot2c_f32_bf16 v41, v130, v63
    v_dot2c_f32_bf16 v42, v131, v62
    v_dot2c_f32_bf16 v43, v131, v63
    s_waitcnt vmcnt(6)
    v_dot2c_f32_bf16 v44, v132, v62
    v_dot2c_f32_bf16 v45, v132, v63
    v_dot2c_f32_bf16 v46, v133, v62
    v_dot2c_f32_bf16 v47, v133, v63
    v_dot2c_f32_bf16 v48, v134, v62
    v_dot2c_f32_bf16 v49, v134, v63
    v_dot2c_f32_bf16 v50, v135, v62
    v_dot2c_f32_bf16 v51, v135, v63
    s_waitcnt vmcnt(5)
    v_and_b32 v60, 0xffff, v55
    v_lshlrev_b32 v61, 16, v55
    v_lshrrev_b32 v62, 16, v55
    v_and_b32 v63, 0xffff0000, v55
    v_dot2c_f32_bf16 v28, v136, v60
    v_dot2c_f32_bf16 v29, v136, v61
    v_dot2c_f32_bf16 v30, v137, v60
    v_dot2c_f32_bf16 v31, v137, v61
    v_dot2c_f32_bf16 v32, v138, v60
    v_dot2c_f32_bf16 v33, v138, v61
    v_dot2c_f32_bf16 v34, v139, v60
    v_dot2c_f32_bf16 v35, v139, v61
    s_waitcnt vmcnt(4)
    v_dot2c_f32_bf16 v36, v140, v60
    v_dot2c_f32_bf16 v37, v140, v61
    v_dot2c_f32_bf16 v38, v141, v60
    v_dot2c_f32_bf16 v39, v141, v61
    v_dot2c_f32_bf16 v40, v142, v60
    v_dot2c_f32_bf16 v41, v142, v61
    v_dot2c_f32_bf16 v42, v143, v60
    v_dot2c_f32_bf16 v43, v143, v61
    s_waitcnt vmcnt(3)
    v_dot2c_f32_bf16 v44, v144, v60
    v_dot2c_f32_bf16 v45, v144, v61
    v_dot2c_f32_bf16 v46, v145, v60
    v_dot2c_f32_bf16 v47, v145, v61
    v_dot2c_f32_bf16 v48, v146, v60
    v_dot2c_f32_bf16 v49, v146, v61
    v_dot2c_f32_bf16 v50, v147, v60
    v_dot2c_f32_bf16 v51, v147, v61
    s_waitcnt vmcnt(2)
    v_dot2c_f32_bf16 v28, v148, v62
    v_dot2c_f32_bf16 v29, v148, v63
    v_dot2c_f32_bf16 v30, v149, v62
    v_dot2c_f32_bf16 v31, v149, v63
    v_dot2c_f32_bf16 v32, v150, v62
    v_dot2c_f32_bf16 v33, v150, v63
    v_dot2c_f32_bf16 v34, v151, v62
    v_dot2c_f32_bf16 v35, v151, v63
    s_waitcnt vmcnt(1)
    v_dot2c_f32_bf16 v36, v152, v62
    v_dot2c_f32_bf16 v37, v152, v63
    v_dot2c_f32_bf16 v38, v153, v62
    v_dot2c_f32_bf16 v39, v153, v63
    v_dot2c_f32_bf16 v40, v154, v62
    v_dot2c_f32_bf16 v41, v154, v63
    v_dot2c_f32_bf16 v42, v155, v62
    v_dot2c_f32_bf16 v43, v155, v63
    s_waitcnt vmcnt(0)
    v_dot2c_f32_bf16 v44, v156, v62
    v_dot2c_f32_bf16 v45, v156, v63
    v_dot2c_f32_bf16 v46, v157, v62
    v_dot2c_f32_bf16 v47, v157, v63
    v_dot2c_f32_bf16 v48, v158, v62
    v_dot2c_f32_bf16 v49, v158, v63
    v_dot2c_f32_bf16 v50, v159, v62
    v_dot2c_f32_bf16 v51, v159, v63
    ds_write_b32 v7, v19 offset:8
    v_permlane32_swap_b32 v28, v32
    v_permlane32_swap_b32 v29, v33
    v_permlane32_swap_b32 v30, v34
    v_permlane32_swap_b32 v31, v35
    v_permlane32_swap_b32 v36, v40
    v_permlane32_swap_b32 v37, v41
    v_permlane32_swap_b32 v38, v42
    v_permlane32_swap_b32 v39, v43
    v_permlane32_swap_b32 v44, v48
    v_permlane32_swap_b32 v45, v49
    v_permlane32_swap_b32 v46, v50
    v_permlane32_swap_b32 v47, v51
    v_pk_add_f32 v[28:29], v[28:29], v[32:33]
    v_pk_add_f32 v[30:31], v[30:31], v[34:35]
    v_pk_add_f32 v[36:37], v[36:37], v[40:41]
    v_pk_add_f32 v[38:39], v[38:39], v[42:43]
    v_pk_add_f32 v[32:33], v[44:45], v[48:49]
    v_pk_add_f32 v[34:35], v[46:47], v[50:51]
    v_pk_add_f32 v[44:45], v[44:45], v[48:49]
    v_pk_add_f32 v[46:47], v[46:47], v[50:51]
    ds_read_b32 v8, v26 offset:40
    ds_read_b128 v[52:55], v25 offset:13824
    v_permlane16_swap_b32 v28, v36
    v_permlane16_swap_b32 v29, v37
    v_permlane16_swap_b32 v30, v38
    v_permlane16_swap_b32 v31, v39
    v_permlane16_swap_b32 v44, v32
    v_permlane16_swap_b32 v45, v33
    v_permlane16_swap_b32 v46, v34
    v_permlane16_swap_b32 v47, v35
    v_pk_add_f32 v[28:29], v[28:29], v[36:37]
    v_pk_add_f32 v[30:31], v[30:31], v[38:39]
    v_pk_add_f32 v[44:45], v[44:45], v[32:33]
    v_pk_add_f32 v[46:47], v[46:47], v[34:35]
    v_add_f32_dpp v60, v28, v28 row_ror:8 row_mask:0xf bank_mask:0x3
    v_add_f32_dpp v61, v29, v29 row_ror:8 row_mask:0xf bank_mask:0x3
    v_add_f32_dpp v62, v30, v30 row_ror:8 row_mask:0xf bank_mask:0x3
    v_add_f32_dpp v63, v31, v31 row_ror:8 row_mask:0xf bank_mask:0x3
    v_add_f32_dpp v60, v44, v44 row_ror:8 row_mask:0xf bank_mask:0xc
    v_add_f32_dpp v61, v45, v45 row_ror:8 row_mask:0xf bank_mask:0xc
    v_add_f32_dpp v62, v46, v46 row_ror:8 row_mask:0xf bank_mask:0xc
    v_add_f32_dpp v63, v47, v47 row_ror:8 row_mask:0xf bank_mask:0xc
    s_waitcnt lgkmcnt(0)
    v_readfirstlane_b32 s63, v8
    s_cmp_lg_u32 s63, 0
    s_cbranch_scc1 L_spub
    ds_write_b128 v24, v[60:63] offset:13824
    ds_write_b32 v7, v27 offset:40
    s_mov_b64 exec, 1
    ds_add_rtn_u32 v9, v12, v27 offset:36
    s_mov_b64 exec, -1
    ds_read_b128 v[52:55], v25 offset:13824
    s_waitcnt lgkmcnt(0)
    v_readfirstlane_b32 s63, v9
    s_cmp_eq_u32 s63, 0
    s_cbranch_scc1 L_sdone
L_spub:
    v_pk_add_f32 v[60:61], v[60:61], v[52:53]
    v_pk_add_f32 v[62:63], v[62:63], v[54:55]
    v_min_u32 v60, -2, v60
    v_min_u32 v61, -2, v61
    v_min_u32 v62, -2, v62
    v_min_u32 v63, -2, v63
    s_mov_b32 exec_lo, 0xffffff
    s_mov_b32 exec_hi, 0xffffff
    s_cmp_eq_u32 s54, 0
    s_cbranch_scc1 L_spub_far
    buffer_store_dwordx4 v[60:63], v18, s[12:15], s57 offen
    s_branch L_sdone
L_spub_far:
    buffer_store_dwordx4 v[60:63], v18, s[12:15], s57 offen sc1
L_sdone:
    s_endpgm
L_helperA:
    s_setprio 3
    v_mul_u32_u24 v3, 0x18000, v1
    v_lshl_add_u32 v3, v2, 4, v3
    v_lshlrev_b32 v19, 4, v0
    v_lshlrev_b32 v10, 2, v0
    s_mul_i32 s42, s40, 786432
    s_mul_i32 s43, s4, 384
    s_add_u32 s42, s42, s43
    s_lshl_b32 s6, s41, 7
    s_add_u32 s42, s42, s6
    s_waitcnt lgkmcnt(0)
    s_mov_b32 s8, s16
    s_mov_b32 s9, s17
    s_mov_b32 s10, 1280
    s_mov_b32 s11, 0x20000
    s_mov_b32 s12, s22
    s_mov_b32 s13, s23
    s_mov_b32 s14, 7864320
    s_mov_b32 s15, 0x20000
    buffer_load_dwordx4 v[20:23], v19, s[8:11], 0 offen
    buffer_load_dword v24, v10, s[8:11], 0 offen offset:1024
    buffer_load_dwordx4 v[192:195], v3, s[12:15], s42 offen nt
    s_add_u32 s42, s42, 12288
    buffer_load_dwordx4 v[196:199], v3, s[12:15], s42 offen nt
    s_add_u32 s42, s42, 12288
    buffer_load_dwordx4 v[200:203], v3, s[12:15], s42 offen nt
    s_add_u32 s42, s42, 12288
    buffer_load_dwordx4 v[204:207], v3, s[12:15], s42 offen nt
    s_add_u32 s42, s42, 12288
    buffer_load_dwordx4 v[208:211], v3, s[12:15], s42 offen nt
    s_add_u32 s42, s42, 12288
    buffer_load_dwordx4 v[212:215], v3, s[12:15], s42 offen nt
    s_add_u32 s42, s42, 12288
    buffer_load_dwordx4 v[216:219], v3, s[12:15], s42 offen nt
    s_add_u32 s42, s42, 12288
    buffer_load_dwordx4 v[220:223], v3, s[12:15], s42 offen nt
    s_mov_b32 s6, 3080192
    s_load_dword s60, s[38:39], s6
    s_barrier
    s_mov_b32 s44, s38
    s_mov_b32 s45, s39
    s_mov_b32 s46, 4194304
    s_mov_b32 s47, 0x20000
    s_lshr_b32 s52, s5, 1
    s_and_b32 s53, s5, 1
    s_mul_i32 s54, s52, 43691
    s_lshr_b32 s54, s54, 17
    s_mul_i32 s55, s54, 3
    s_sub_u32 s55, s52, s55
    s_cmp_eq_u32 s54, 3
    s_cselect_b32 s48, s28, s30
    s_cselect_b32 s49, s29, s31
    s_add_u32 s6, s54, 1
    s_mul_i32 s6, s6, 3072
    s_movk_i32 s56, 0xc00
    s_cmp_lt_u32 s54, 3
    s_cselect_b32 s48, s22, s48
    s_cselect_b32 s49, s23, s49
    s_cselect_b32 s56, 12288, s56
    s_cselect_b32 s6, s6, 0
    s_mul_i32 s50, s56, 640
    s_cmp_lt_u32 s54, 5
    s_cselect_b32 s50, s50, 0
    s_mov_b32 s51, 0x20000
    s_add_u32 s42, s43, s6
    s_lshl_b32 s6, s55, 7
    s_add_u32 s42, s42, s6
    s_mul_i32 s6, s56, 320
    s_mul_i32 s6, s6, s53
    s_add_u32 s42, s42, s6
    s_mul_i32 s57, s56, 57
    s_lshl_b32 s6, s56, 3
    v_mul_u32_u24 v25, s6, v1
    v_lshl_add_u32 v25, v2, 4, v25
    v_lshrrev_b32 v18, 4, v0
    v_lshlrev_b32 v18, 7, v18
    v_lshl_add_u32 v18, v2, 4, v18
    v_and_b32 v11, 3, v1
    v_lshlrev_b32 v9, 4, v2
    v_lshl_add_u32 v9, v11, 2, v9
    v_and_b32 v11, 31, v0
    v_lshlrev_b32 v11, 4, v11
    v_lshrrev_b32 v12, 5, v0
    v_mul_u32_u24 v66, 1536, v12
    v_add_u32 v66, v66, v11
    v_mul_u32_u24 v67, 7680, v12
    v_add_u32 v67, v67, v11
    s_lshl_b32 s6, s40, 7
    v_lshl_add_u32 v26, v1, 4, s6
    s_mul_i32 s6, s53, 640
    v_lshl_add_u32 v27, v1, 4, s6
    v_mov_b32 v84, 0
    v_mov_b32 v85, 0
    v_mov_b32 v86, 0
    v_mov_b32 v87, 0
    v_mov_b32 v88, 0
    v_mov_b32 v89, 0
    v_mov_b32 v90, 0
    v_mov_b32 v91, 0
    s_waitcnt vmcnt(8)
    buffer_load_dwordx4 v[96:99], v25, s[48:51], s42 offen nt
    s_add_u32 s42, s42, s56
    buffer_load_dwordx4 v[100:103], v25, s[48:51], s42 offen nt
    s_add_u32 s42, s42, s56
    buffer_load_dwordx4 v[104:107], v25, s[48:51], s42 offen nt
    s_add_u32 s42, s42, s56
    buffer_load_dwordx4 v[108:111], v25, s[48:51], s42 offen nt
    s_add_u32 s42, s42, s56
    buffer_load_dwordx4 v[112:115], v25, s[48:51], s42 offen nt
    s_add_u32 s42, s42, s56
    buffer_load_dwordx4 v[116:119], v25, s[48:51], s42 offen nt
    s_add_u32 s42, s42, s56
    buffer_load_dwordx4 v[120:123], v25, s[48:51], s42 offen nt
    s_add_u32 s42, s42, s56
    buffer_load_dwordx4 v[124:127], v25, s[48:51], s42 offen nt
    s_add_u32 s42, s42, s57
    buffer_load_dwordx4 v[128:131], v25, s[48:51], s42 offen nt
    s_add_u32 s42, s42, s56
    buffer_load_dwordx4 v[132:135], v25, s[48:51], s42 offen nt
    s_add_u32 s42, s42, s56
    v_lshlrev_b32 v52, 16, v20
    v_and_b32 v53, 0xffff0000, v20
    v_lshlrev_b32 v54, 16, v21
    v_and_b32 v55, 0xffff0000, v21
    v_lshlrev_b32 v56, 16, v22
    v_and_b32 v57, 0xffff0000, v22
    v_lshlrev_b32 v58, 16, v23
    v_and_b32 v59, 0xffff0000, v23
    v_lshlrev_b32 v60, 16, v24
    v_and_b32 v61, 0xffff0000, v24
    v_add_f32 v62, v52, v53
    v_add_f32 v62, v62, v54
    v_add_f32 v62, v62, v55
    v_add_f32 v62, v62, v56
    v_add_f32 v62, v62, v57
    v_add_f32 v62, v62, v58
    v_add_f32 v62, v62, v59
    v_add_f32 v62, v62, v60
    v_add_f32 v62, v62, v61
    s_nop 1
    v_add_f32_dpp v62, v62, v62 quad_perm:[1,0,3,2] row_mask:0xf bank_mask:0xf
    s_nop 1
    v_add_f32_dpp v62, v62, v62 quad_perm:[2,3,0,1] row_mask:0xf bank_mask:0xf
    s_nop 1
    v_add_f32_dpp v62, v62, v62 row_half_mirror row_mask:0xf bank_mask:0xf
    s_nop 1
    v_add_f32_dpp v62, v62, v62 row_mirror row_mask:0xf bank_mask:0xf
    v_mov_b32 v63, v62
    s_nop 1
    v_permlane16_swap_b32 v62, v63
    s_nop 1
    v_add_f32 v62, v62, v63
    v_mov_b32 v63, v62
    s_nop 1
    v_permlane32_swap_b32 v62, v63
    s_nop 1
    v_add_f32 v62, v62, v63
    v_mul_f32 v62, 0x3acccccd, v62
    v_mov_b32 v64, 0
    v_sub_f32 v65, v52, v62
    v_fmac_f32 v64, v65, v65
    v_sub_f32 v65, v53, v62
    v_fmac_f32 v64, v65, v65
    v_sub_f32 v65, v54, v62
    v_fmac_f32 v64, v65, v65
    v_sub_f32 v65, v55, v62
    v_fmac_f32 v64, v65, v65
    v_sub_f32 v65, v56, v62
    v_fmac_f32 v64, v65, v65
    v_sub_f32 v65, v57, v62
    v_fmac_f32 v64, v65, v65
    v_sub_f32 v65, v58, v62
    v_fmac_f32 v64, v65, v65
    v_sub_f32 v65, v59, v62
    v_fmac_f32 v64, v65, v65
    v_sub_f32 v65, v60, v62
    v_fmac_f32 v64, v65, v65
    v_sub_f32 v65, v61, v62
    v_fmac_f32 v64, v65, v65
    s_nop 1
    v_add_f32_dpp v64, v64, v64 quad_perm:[1,0,3,2] row_mask:0xf bank_mask:0xf
    s_nop 1
    v_add_f32_dpp v64, v64, v64 quad_perm:[2,3,0,1] row_mask:0xf bank_mask:0xf
    s_nop 1
    v_add_f32_dpp v64, v64, v64 row_half_mirror row_mask:0xf bank_mask:0xf
    s_nop 1
    v_add_f32_dpp v64, v64, v64 row_mirror row_mask:0xf bank_mask:0xf
    v_mov_b32 v63, v64
    s_nop 1
    v_permlane16_swap_b32 v64, v63
    s_nop 1
    v_add_f32 v64, v64, v63
    v_mov_b32 v63, v64
    s_nop 1
    v_permlane32_swap_b32 v64, v63
    s_nop 1
    v_add_f32 v64, v64, v63
    v_mul_f32 v64, 0x3acccccd, v64
    v_cvt_pk_bf16_f32 v64, v64, v64
    v_and_b32 v64, 0xffff0000, v64
    v_cvt_pk_bf16_f32 v62, v62, v62
    v_and_b32 v62, 0xffff0000, v62
    v_add_f32 v64, 0x3727c5ac, v64
    v_cvt_pk_bf16_f32 v64, v64, v64
    v_and_b32 v64, 0xffff0000, v64
    v_sqrt_f32 v64, v64
    v_sub_f32 v52, v52, v62
    v_sub_f32 v53, v53, v62
    v_sub_f32 v54, v54, v62
    v_sub_f32 v55, v55, v62
    v_sub_f32 v56, v56, v62
    v_sub_f32 v57, v57, v62
    v_sub_f32 v58, v58, v62
    v_sub_f32 v59, v59, v62
    v_sub_f32 v60, v60, v62
    v_sub_f32 v61, v61, v62
    v_cvt_pk_bf16_f32 v64, v64, v64
    v_and_b32 v64, 0xffff0000, v64
    v_rcp_f32 v64, v64
    v_cvt_pk_bf16_f32 v20, v52, v53
    v_cvt_pk_bf16_f32 v21, v54, v55
    v_cvt_pk_bf16_f32 v22, v56, v57
    v_cvt_pk_bf16_f32 v23, v58, v59
    v_cvt_pk_bf16_f32 v24, v60, v61
    v_lshlrev_b32 v52, 16, v20
    v_and_b32 v53, 0xffff0000, v20
    v_lshlrev_b32 v54, 16, v21
    v_and_b32 v55, 0xffff0000, v21
    v_lshlrev_b32 v56, 16, v22
    v_and_b32 v57, 0xffff0000, v22
    v_lshlrev_b32 v58, 16, v23
    v_and_b32 v59, 0xffff0000, v23
    v_lshlrev_b32 v60, 16, v24
    v_and_b32 v61, 0xffff0000, v24
    v_mul_f32 v52, v52, v64
    v_mul_f32 v53, v53, v64
    v_mul_f32 v54, v54, v64
    v_mul_f32 v55, v55, v64
    v_mul_f32 v56, v56, v64
    v_mul_f32 v57, v57, v64
    v_mul_f32 v58, v58, v64
    v_mul_f32 v59, v59, v64
    v_mul_f32 v60, v60, v64
    v_mul_f32 v61, v61, v64
    v_cvt_pk_bf16_f32 v20, v52, v53
    v_cvt_pk_bf16_f32 v21, v54, v55
    v_cvt_pk_bf16_f32 v22, v56, v57
    v_cvt_pk_bf16_f32 v23, v58, v59
    v_cvt_pk_bf16_f32 v24, v60, v61
    ds_write_b128 v19, v[20:23] offset:4352
    ds_write_b32 v10, v24 offset:5376
    ds_read_b128 v[28:31], v26 offset:4352
    ds_read_b128 v[32:35], v27 offset:4352
    ds_read_b128 v[36:39], v27 offset:4480
    ds_read_b128 v[40:43], v27 offset:4608
    ds_read_b128 v[44:47], v27 offset:4736
    ds_read_b128 v[48:51], v27 offset:4864
    s_waitcnt lgkmcnt(0)
    s_add_u32 s60, s60, 0x9e3779b9
    v_and_b32 v68, 0xffff, v28
    v_lshlrev_b32 v69, 16, v28
    v_lshrrev_b32 v70, 16, v28
    v_and_b32 v71, 0xffff0000, v28
    v_and_b32 v72, 0xffff, v29
    v_lshlrev_b32 v73, 16, v29
    v_lshrrev_b32 v74, 16, v29
    v_and_b32 v75, 0xffff0000, v29
    v_and_b32 v76, 0xffff, v30
    v_lshlrev_b32 v77, 16, v30
    v_lshrrev_b32 v78, 16, v30
    v_and_b32 v79, 0xffff0000, v30
    v_and_b32 v80, 0xffff, v31
    v_lshlrev_b32 v81, 16, v31
    v_lshrrev_b32 v82, 16, v31
    v_and_b32 v83, 0xffff0000, v31
    v_mov_b32 v93, s60
    v_mov_b32 v95, s60
    s_waitcnt vmcnt(17)
    v_dot2c_f32_bf16 v84, v192, v68
    v_dot2c_f32_bf16 v85, v192, v69
    v_dot2c_f32_bf16 v86, v193, v68
    v_dot2c_f32_bf16 v87, v193, v69
    v_dot2c_f32_bf16 v88, v194, v68
    v_dot2c_f32_bf16 v89, v194, v69
    v_dot2c_f32_bf16 v90, v195, v68
    v_dot2c_f32_bf16 v91, v195, v69
    s_waitcnt vmcnt(16)
    v_dot2c_f32_bf16 v84, v196, v70
    v_dot2c_f32_bf16 v85, v196, v71
    v_dot2c_f32_bf16 v86, v197, v70
    v_dot2c_f32_bf16 v87, v197, v71
    v_dot2c_f32_bf16 v88, v198, v70
    v_dot2c_f32_bf16 v89, v198, v71
    v_dot2c_f32_bf16 v90, v199, v70
    v_dot2c_f32_bf16 v91, v199, v71
    s_waitcnt vmcnt(15)
    v_dot2c_f32_bf16 v84, v200, v72
    v_dot2c_f32_bf16 v85, v200, v73
    v_dot2c_f32_bf16 v86, v201, v72
    v_dot2c_f32_bf16 v87, v201, v73
    v_dot2c_f32_bf16 v88, v202, v72
    v_dot2c_f32_bf16 v89, v202, v73
    v_dot2c_f32_bf16 v90, v203, v72
    v_dot2c_f32_bf16 v91, v203, v73
    s_waitcnt vmcnt(14)
    v_dot2c_f32_bf16 v84, v204, v74
    v_dot2c_f32_bf16 v85, v204, v75
    v_dot2c_f32_bf16 v86, v205, v74
    v_dot2c_f32_bf16 v87, v205, v75
    v_dot2c_f32_bf16 v88, v206, v74
    v_dot2c_f32_bf16 v89, v206, v75
    v_dot2c_f32_bf16 v90, v207, v74
    v_dot2c_f32_bf16 v91, v207, v75
    s_waitcnt vmcnt(13)
    v_dot2c_f32_bf16 v84, v208, v76
    v_dot2c_f32_bf16 v85, v208, v77
    v_dot2c_f32_bf16 v86, v209, v76
    v_dot2c_f32_bf16 v87, v209, v77
    v_dot2c_f32_bf16 v88, v210, v76
    v_dot2c_f32_bf16 v89, v210, v77
    v_dot2c_f32_bf16 v90, v211, v76
    v_dot2c_f32_bf16 v91, v211, v77
    s_waitcnt vmcnt(12)
    v_dot2c_f32_bf16 v84, v212, v78
    v_dot2c_f32_bf16 v85, v212, v79
    v_dot2c_f32_bf16 v86, v213, v78
    v_dot2c_f32_bf16 v87, v213, v79
    v_dot2c_f32_bf16 v88, v214, v78
    v_dot2c_f32_bf16 v89, v214, v79
    v_dot2c_f32_bf16 v90, v215, v78
    v_dot2c_f32_bf16 v91, v215, v79
    s_waitcnt vmcnt(11)
    v_dot2c_f32_bf16 v84, v216, v80
    v_dot2c_f32_bf16 v85, v216, v81
    v_dot2c_f32_bf16 v86, v217, v80
    v_dot2c_f32_bf16 v87, v217, v81
    v_dot2c_f32_bf16 v88, v218, v80
    v_dot2c_f32_bf16 v89, v218, v81
    v_dot2c_f32_bf16 v90, v219, v80
    v_dot2c_f32_bf16 v91, v219, v81
    s_waitcnt vmcnt(10)
    v_dot2c_f32_bf16 v84, v220, v82
    v_dot2c_f32_bf16 v85, v220, v83
    v_dot2c_f32_bf16 v86, v221, v82
    v_dot2c_f32_bf16 v87, v221, v83
    v_dot2c_f32_bf16 v88, v222, v82
    v_dot2c_f32_bf16 v89, v222, v83
    v_dot2c_f32_bf16 v90, v223, v82
    v_dot2c_f32_bf16 v91, v223, v83
    s_nop 2
    v_permlane32_swap_b32 v84, v88
    v_permlane32_swap_b32 v85, v89
    v_permlane32_swap_b32 v86, v90
    v_permlane32_swap_b32 v87, v91
    s_nop 0
    v_add_f32 v84, v84, v88
    v_add_f32 v85, v85, v89
    v_add_f32 v86, v86, v90
    v_add_f32 v87, v87, v91
    s_nop 1
    v_permlane16_swap_b32 v84, v86
    v_permlane16_swap_b32 v85, v87
    s_nop 0
    v_add_f32 v84, v84, v86
    v_add_f32 v85, v85, v87
    s_nop 1
    v_add_f32_dpp v92, v84, v84 row_ror:8 row_mask:0xf bank_mask:0xf
    v_add_f32_dpp v94, v85, v85 row_ror:8 row_mask:0xf bank_mask:0xf
    s_mul_i32 s58, s4, 15360
    s_lshl_b32 s6, s5, 9
    s_add_u32 s6, s6, s58
    s_cmp_lt_u32 s5, 30
    s_cselect_b32 s6, s6, 4194304
    s_mov_b32 exec_lo, 0x00ff00ff
    s_mov_b32 exec_hi, 0x00ff00ff
    buffer_store_dwordx4 v[92:95], v18, s[44:47], s6 offen sc1
    s_mov_b64 exec, -1
    buffer_load_dwordx4 v[136:139], v25, s[48:51], s42 offen nt
    s_add_u32 s42, s42, s56
    buffer_load_dwordx4 v[140:143], v25, s[48:51], s42 offen nt
    s_add_u32 s42, s42, s56
    buffer_load_dwordx4 v[144:147], v25, s[48:51], s42 offen nt
    s_add_u32 s42, s42, s56
    buffer_load_dwordx4 v[148:151], v25, s[48:51], s42 offen nt
    s_add_u32 s42, s42, s56
    buffer_load_dwordx4 v[152:155], v25, s[48:51], s42 offen nt
    s_add_u32 s42, s42, s56
    buffer_load_dwordx4 v[156:159], v25, s[48:51], s42 offen nt
    s_add_u32 s42, s42, s57
    buffer_load_dwordx4 v[160:163], v25, s[48:51], s42 offen nt
    s_add_u32 s42, s42, s56
    buffer_load_dwordx4 v[164:167], v25, s[48:51], s42 offen nt
    s_add_u32 s42, s42, s56
    buffer_load_dwordx4 v[168:171], v25, s[48:51], s42 offen nt
    s_add_u32 s42, s42, s56
    buffer_load_dwordx4 v[172:175], v25, s[48:51], s42 offen nt
    s_add_u32 s42, s42, s56
    buffer_load_dwordx4 v[176:179], v25, s[48:51], s42 offen nt
    s_add_u32 s42, s42, s56
    buffer_load_dwordx4 v[180:183], v25, s[48:51], s42 offen nt
    s_add_u32 s42, s42, s56
    s_waitcnt lgkmcnt(0)
    v_mov_b32 v4, 32
    v_mov_b32 v5, s60
    ds_write_b32 v4, v5
    s_waitcnt lgkmcnt(0)
    v_mov_b32 v4, 24
    v_mov_b32 v5, 1
    ds_write_b32 v4, v5
    v_mov_b32 v84, 0
    v_mov_b32 v85, 0
    v_mov_b32 v86, 0
    v_mov_b32 v87, 0
    v_mov_b32 v88, 0
    v_mov_b32 v89, 0
    v_mov_b32 v90, 0
    v_mov_b32 v91, 0
    s_waitcnt vmcnt(21)
    buffer_load_dwordx4 v[184:187], v25, s[48:51], s42 offen nt
    s_add_u32 s42, s42, s56
    v_and_b32 v68, 0xffff, v32
    v_lshlrev_b32 v69, 16, v32
    v_lshrrev_b32 v70, 16, v32
    v_and_b32 v71, 0xffff0000, v32
    v_and_b32 v72, 0xffff, v33
    v_lshlrev_b32 v73, 16, v33
    v_lshrrev_b32 v74, 16, v33
    v_and_b32 v75, 0xffff0000, v33
    v_and_b32 v76, 0xffff, v34
    v_lshlrev_b32 v77, 16, v34
    v_lshrrev_b32 v78, 16, v34
    v_and_b32 v79, 0xffff0000, v34
    v_and_b32 v80, 0xffff, v35
    v_lshlrev_b32 v81, 16, v35
    v_lshrrev_b32 v82, 16, v35
    v_and_b32 v83, 0xffff0000, v35
    v_dot2c_f32_bf16 v84, v96, v68
    v_dot2c_f32_bf16 v85, v96, v69
    v_dot2c_f32_bf16 v86, v97, v68
    v_dot2c_f32_bf16 v87, v97, v69
    v_dot2c_f32_bf16 v88, v98, v68
    v_dot2c_f32_bf16 v89, v98, v69
    v_dot2c_f32_bf16 v90, v99, v68
    v_dot2c_f32_bf16 v91, v99, v69
    s_waitcnt vmcnt(21)
    buffer_load_dwordx4 v[188:191], v25, s[48:51], s42 offen nt
    s_add_u32 s42, s42, s57
    v_dot2c_f32_bf16 v84, v100, v70
    v_dot2c_f32_bf16 v85, v100, v71
    v_dot2c_f32_bf16 v86, v101, v70
    v_dot2c_f32_bf16 v87, v101, v71
    v_dot2c_f32_bf16 v88, v102, v70
    v_dot2c_f32_bf16 v89, v102, v71
    v_dot2c_f32_bf16 v90, v103, v70
    v_dot2c_f32_bf16 v91, v103, v71
    s_waitcnt vmcnt(21)
    buffer_load_dwordx4 v[96:99], v25, s[48:51], s42 offen nt
    s_add_u32 s42, s42, s56
    v_dot2c_f32_bf16 v84, v104, v72
    v_dot2c_f32_bf16 v85, v104, v73
    v_dot2c_f32_bf16 v86, v105, v72
    v_dot2c_f32_bf16 v87, v105, v73
    v_dot2c_f32_bf16 v88, v106, v72
    v_dot2c_f32_bf16 v89, v106, v73
    v_dot2c_f32_bf16 v90, v107, v72
    v_dot2c_f32_bf16 v91, v107, v73
    s_waitcnt vmcnt(21)
    buffer_load_dwordx4 v[100:103], v25, s[48:51], s42 offen nt
    s_add_u32 s42, s42, s56
    v_dot2c_f32_bf16 v84, v108, v74
    v_dot2c_f32_bf16 v85, v108, v75
    v_dot2c_f32_bf16 v86, v109, v74
    v_dot2c_f32_bf16 v87, v109, v75
    v_dot2c_f32_bf16 v88, v110, v74
    v_dot2c_f32_bf16 v89, v110, v75
    v_dot2c_f32_bf16 v90, v111, v74
    v_dot2c_f32_bf16 v91, v111, v75
    s_waitcnt vmcnt(21)
    buffer_load_dwordx4 v[104:107], v25, s[48:51], s42 offen nt
    s_add_u32 s42, s42, s56
    v_dot2c_f32_bf16 v84, v112, v76
    v_dot2c_f32_bf16 v85, v112, v77
    v_dot2c_f32_bf16 v86, v113, v76
    v_dot2c_f32_bf16 v87, v113, v77
    v_dot2c_f32_bf16 v88, v114, v76
    v_dot2c_f32_bf16 v89, v114, v77
    v_dot2c_f32_bf16 v90, v115, v76
    v_dot2c_f32_bf16 v91, v115, v77
    s_waitcnt vmcnt(21)
    buffer_load_dwordx4 v[108:111], v25, s[48:51], s42 offen nt
    s_add_u32 s42, s42, s56
    v_dot2c_f32_bf16 v84, v116, v78
    v_dot2c_f32_bf16 v85, v116, v79
    v_dot2c_f32_bf16 v86, v117, v78
    v_dot2c_f32_bf16 v87, v117, v79
    v_dot2c_f32_bf16 v88, v118, v78
    v_dot2c_f32_bf16 v89, v118, v79
    v_dot2c_f32_bf16 v90, v119, v78
    v_dot2c_f32_bf16 v91, v119, v79
    s_waitcnt vmcnt(21)
    buffer_load_dwordx4 v[112:115], v25, s[48:51], s42 offen nt
    s_add_u32 s42, s42, s56
    v_dot2c_f32_bf16 v84, v120, v80
    v_dot2c_f32_bf16 v85, v120, v81
    v_dot2c_f32_bf16 v86, v121, v80
    v_dot2c_f32_bf16 v87, v121, v81
    v_dot2c_f32_bf16 v88, v122, v80
    v_dot2c_f32_bf16 v89, v122, v81
    v_dot2c_f32_bf16 v90, v123, v80
    v_dot2c_f32_bf16 v91, v123, v81
    s_waitcnt vmcnt(21)
    buffer_load_dwordx4 v[116:119], v25, s[48:51], s42 offen nt
    s_add_u32 s42, s42, s56
    v_dot2c_f32_bf16 v84, v124, v82
    v_dot2c_f32_bf16 v85, v124, v83
    v_dot2c_f32_bf16 v86, v125, v82
    v_dot2c_f32_bf16 v87, v125, v83
    v_dot2c_f32_bf16 v88, v126, v82
    v_dot2c_f32_bf16 v89, v126, v83
    v_dot2c_f32_bf16 v90, v127, v82
    v_dot2c_f32_bf16 v91, v127, v83
    s_waitcnt vmcnt(21)
    buffer_load_dwordx4 v[120:123], v25, s[48:51], s42 offen nt
    s_add_u32 s42, s42, s56
    v_and_b32 v68, 0xffff, v36
    v_lshlrev_b32 v69, 16, v36
    v_lshrrev_b32 v70, 16, v36
    v_and_b32 v71, 0xffff0000, v36
    v_and_b32 v72, 0xffff, v37
    v_lshlrev_b32 v73, 16, v37
    v_lshrrev_b32 v74, 16, v37
    v_and_b32 v75, 0xffff0000, v37
    v_and_b32 v76, 0xffff, v38
    v_lshlrev_b32 v77, 16, v38
    v_lshrrev_b32 v78, 16, v38
    v_and_b32 v79, 0xffff0000, v38
    v_and_b32 v80, 0xffff, v39
    v_lshlrev_b32 v81, 16, v39
    v_lshrrev_b32 v82, 16, v39
    v_and_b32 v83, 0xffff0000, v39
    v_dot2c_f32_bf16 v84, v128, v68
    v_dot2c_f32_bf16 v85, v128, v69
    v_dot2c_f32_bf16 v86, v129, v68
    v_dot2c_f32_bf16 v87, v129, v69
    v_dot2c_f32_bf16 v88, v130, v68
    v_dot2c_f32_bf16 v89, v130, v69
    v_dot2c_f32_bf16 v90, v131, v68
    v_dot2c_f32_bf16 v91, v131, v69
    s_waitcnt vmcnt(21)
    buffer_load_dwordx4 v[124:127], v25, s[48:51], s42 offen nt
    s_add_u32 s42, s42, s57
    v_dot2c_f32_bf16 v84, v132, v70
    v_dot2c_f32_bf16 v85, v132, v71
    v_dot2c_f32_bf16 v86, v133, v70
    v_dot2c_f32_bf16 v87, v133, v71
    v_dot2c_f32_bf16 v88, v134, v70
    v_dot2c_f32_bf16 v89, v134, v71
    v_dot2c_f32_bf16 v90, v135, v70
    v_dot2c_f32_bf16 v91, v135, v71
    s_waitcnt vmcnt(21)
    buffer_load_dwordx4 v[128:131], v25, s[48:51], s42 offen nt
    s_add_u32 s42, s42, s56
    v_dot2c_f32_bf16 v84, v136, v72
    v_dot2c_f32_bf16 v85, v136, v73
    v_dot2c_f32_bf16 v86, v137, v72
    v_dot2c_f32_bf16 v87, v137, v73
    v_dot2c_f32_bf16 v88, v138, v72
    v_dot2c_f32_bf16 v89, v138, v73
    v_dot2c_f32_bf16 v90, v139, v72
    v_dot2c_f32_bf16 v91, v139, v73
    s_waitcnt vmcnt(21)
    buffer_load_dwordx4 v[132:135], v25, s[48:51], s42 offen nt
    s_add_u32 s42, s42, s56
    v_dot2c_f32_bf16 v84, v140, v74
    v_dot2c_f32_bf16 v85, v140, v75
    v_dot2c_f32_bf16 v86, v141, v74
    v_dot2c_f32_bf16 v87, v141, v75
    v_dot2c_f32_bf16 v88, v142, v74
    v_dot2c_f32_bf16 v89, v142, v75
    v_dot2c_f32_bf16 v90, v143, v74
    v_dot2c_f32_bf16 v91, v143, v75
    s_waitcnt vmcnt(21)
    buffer_load_dwordx4 v[136:139], v25, s[48:51], s42 offen nt
    s_add_u32 s42, s42, s56
    v_dot2c_f32_bf16 v84, v144, v76
    v_dot2c_f32_bf16 v85, v144, v77
    v_dot2c_f32_bf16 v86, v145, v76
    v_dot2c_f32_bf16 v87, v145, v77
    v_dot2c_f32_bf16 v88, v146, v76
    v_dot2c_f32_bf16 v89, v146, v77
    v_dot2c_f32_bf16 v90, v147, v76
    v_dot2c_f32_bf16 v91, v147, v77
    s_waitcnt vmcnt(21)
    buffer_load_dwordx4 v[140:143], v25, s[48:51], s42 offen nt
    s_add_u32 s42, s42, s56
    v_dot2c_f32_bf16 v84, v148, v78
    v_dot2c_f32_bf16 v85, v148, v79
    v_dot2c_f32_bf16 v86, v149, v78
    v_dot2c_f32_bf16 v87, v149, v79
    v_dot2c_f32_bf16 v88, v150, v78
    v_dot2c_f32_bf16 v89, v150, v79
    v_dot2c_f32_bf16 v90, v151, v78
    v_dot2c_f32_bf16 v91, v151, v79
    s_waitcnt vmcnt(21)
    buffer_load_dwordx4 v[144:147], v25, s[48:51], s42 offen nt
    s_add_u32 s42, s42, s56
    v_dot2c_f32_bf16 v84, v152, v80
    v_dot2c_f32_bf16 v85, v152, v81
    v_dot2c_f32_bf16 v86, v153, v80
    v_dot2c_f32_bf16 v87, v153, v81
    v_dot2c_f32_bf16 v88, v154, v80
    v_dot2c_f32_bf16 v89, v154, v81
    v_dot2c_f32_bf16 v90, v155, v80
    v_dot2c_f32_bf16 v91, v155, v81
    s_waitcnt vmcnt(21)
    buffer_load_dwordx4 v[148:151], v25, s[48:51], s42 offen nt
    s_add_u32 s42, s42, s56
    v_dot2c_f32_bf16 v84, v156, v82
    v_dot2c_f32_bf16 v85, v156, v83
    v_dot2c_f32_bf16 v86, v157, v82
    v_dot2c_f32_bf16 v87, v157, v83
    v_dot2c_f32_bf16 v88, v158, v82
    v_dot2c_f32_bf16 v89, v158, v83
    v_dot2c_f32_bf16 v90, v159, v82
    v_dot2c_f32_bf16 v91, v159, v83
    s_waitcnt vmcnt(21)
    buffer_load_dwordx4 v[152:155], v25, s[48:51], s42 offen nt
    s_add_u32 s42, s42, s56
    v_and_b32 v68, 0xffff, v40
    v_lshlrev_b32 v69, 16, v40
    v_lshrrev_b32 v70, 16, v40
    v_and_b32 v71, 0xffff0000, v40
    v_and_b32 v72, 0xffff, v41
    v_lshlrev_b32 v73, 16, v41
    v_lshrrev_b32 v74, 16, v41
    v_and_b32 v75, 0xffff0000, v41
    v_and_b32 v76, 0xffff, v42
    v_lshlrev_b32 v77, 16, v42
    v_lshrrev_b32 v78, 16, v42
    v_and_b32 v79, 0xffff0000, v42
    v_and_b32 v80, 0xffff, v43
    v_lshlrev_b32 v81, 16, v43
    v_lshrrev_b32 v82, 16, v43
    v_and_b32 v83, 0xffff0000, v43
    v_dot2c_f32_bf16 v84, v160, v68
    v_dot2c_f32_bf16 v85, v160, v69
    v_dot2c_f32_bf16 v86, v161, v68
    v_dot2c_f32_bf16 v87, v161, v69
    v_dot2c_f32_bf16 v88, v162, v68
    v_dot2c_f32_bf16 v89, v162, v69
    v_dot2c_f32_bf16 v90, v163, v68
    v_dot2c_f32_bf16 v91, v163, v69
    s_waitcnt vmcnt(21)
    buffer_load_dwordx4 v[156:159], v25, s[48:51], s42 offen nt
    v_mov_b32 v4, 28
    v_mov_b32 v5, 1
    ds_write_b32 v4, v5
    v_dot2c_f32_bf16 v84, v164, v70
    v_dot2c_f32_bf16 v85, v164, v71
    v_dot2c_f32_bf16 v86, v165, v70
    v_dot2c_f32_bf16 v87, v165, v71
    v_dot2c_f32_bf16 v88, v166, v70
    v_dot2c_f32_bf16 v89, v166, v71
    v_dot2c_f32_bf16 v90, v167, v70
    v_dot2c_f32_bf16 v91, v167, v71
    s_add_u32 s84, s58, 0
    s_add_u32 s85, s58, 3072
    s_add_u32 s86, s58, 6144
    s_add_u32 s87, s58, 9216
    s_add_u32 s88, s58, 12288
    s_mov_b32 s62, 400000
    buffer_load_dwordx4 v[192:195], v66, s[44:47], s84 offen offset:0 sc1
    buffer_load_dwordx4 v[196:199], v66, s[44:47], s84 offen offset:512 sc1
    buffer_load_dwordx4 v[200:203], v66, s[44:47], s84 offen offset:1024 sc1
    buffer_load_dwordx4 v[204:207], v66, s[44:47], s85 offen offset:0 sc1
    buffer_load_dwordx4 v[208:211], v66, s[44:47], s85 offen offset:512 sc1
    buffer_load_dwordx4 v[212:215], v66, s[44:47], s85 offen offset:1024 sc1
    buffer_load_dwordx4 v[216:219], v66, s[44:47], s86 offen offset:0 sc1
    buffer_load_dwordx4 v[220:223], v66, s[44:47], s86 offen offset:512 sc1
    buffer_load_dwordx4 v[224:227], v66, s[44:47], s86 offen offset:1024 sc1
    buffer_load_dwordx4 v[228:231], v66, s[44:47], s87 offen offset:0 sc1
    buffer_load_dwordx4 v[232:235], v66, s[44:47], s87 offen offset:512 sc1
    buffer_load_dwordx4 v[236:239], v66, s[44:47], s87 offen offset:1024 sc1
    buffer_load_dwordx4 v[240:243], v66, s[44:47], s88 offen offset:0 sc1
    buffer_load_dwordx4 v[244:247], v66, s[44:47], s88 offen offset:512 sc1
    buffer_load_dwordx4 v[248:251], v66, s[44:47], s88 offen offset:1024 sc1
    s_waitcnt vmcnt(36)
    v_dot2c_f32_bf16 v84, v168, v72
    v_dot2c_f32_bf16 v85, v168, v73
    v_dot2c_f32_bf16 v86, v169, v72
    v_dot2c_f32_bf16 v87, v169, v73
    v_dot2c_f32_bf16 v88, v170, v72
    v_dot2c_f32_bf16 v89, v170, v73
    v_dot2c_f32_bf16 v90, v171, v72
    v_dot2c_f32_bf16 v91, v171, v73
    s_waitcnt vmcnt(35)
    v_dot2c_f32_bf16 v84, v172, v74
    v_dot2c_f32_bf16 v85, v172, v75
    v_dot2c_f32_bf16 v86, v173, v74
    v_dot2c_f32_bf16 v87, v173, v75
    v_dot2c_f32_bf16 v88, v174, v74
    v_dot2c_f32_bf16 v89, v174, v75
    v_dot2c_f32_bf16 v90, v175, v74
    v_dot2c_f32_bf16 v91, v175, v75
    s_waitcnt vmcnt(34)
    v_dot2c_f32_bf16 v84, v176, v76
    v_dot2c_f32_bf16 v85, v176, v77
    v_dot2c_f32_bf16 v86, v177, v76
    v_dot2c_f32_bf16 v87, v177, v77
    v_dot2c_f32_bf16 v88, v178, v76
    v_dot2c_f32_bf16 v89, v178, v77
    v_dot2c_f32_bf16 v90, v179, v76
    v_dot2c_f32_bf16 v91, v179, v77
    s_waitcnt vmcnt(33)
    v_dot2c_f32_bf16 v84, v180, v78
    v_dot2c_f32_bf16 v85, v180, v79
    v_dot2c_f32_bf16 v86, v181, v78
    v_dot2c_f32_bf16 v87, v181, v79
    v_dot2c_f32_bf16 v88, v182, v78
    v_dot2c_f32_bf16 v89, v182, v79
    v_dot2c_f32_bf16 v90, v183, v78
    v_dot2c_f32_bf16 v91, v183, v79
    s_waitcnt vmcnt(32)
    v_dot2c_f32_bf16 v84, v184, v80
    v_dot2c_f32_bf16 v85, v184, v81
    v_dot2c_f32_bf16 v86, v185, v80
    v_dot2c_f32_bf16 v87, v185, v81
    v_dot2c_f32_bf16 v88, v186, v80
    v_dot2c_f32_bf16 v89, v186, v81
    v_dot2c_f32_bf16 v90, v187, v80
    v_dot2c_f32_bf16 v91, v187, v81
    s_waitcnt vmcnt(31)
    v_dot2c_f32_bf16 v84, v188, v82
    v_dot2c_f32_bf16 v85, v188, v83
    v_dot2c_f32_bf16 v86, v189, v82
    v_dot2c_f32_bf16 v87, v189, v83
    v_dot2c_f32_bf16 v88, v190, v82
    v_dot2c_f32_bf16 v89, v190, v83
    v_dot2c_f32_bf16 v90, v191, v82
    v_dot2c_f32_bf16 v91, v191, v83
    s_waitcnt vmcnt(30)
    v_and_b32 v68, 0xffff, v44
    v_lshlrev_b32 v69, 16, v44
    v_lshrrev_b32 v70, 16, v44
    v_and_b32 v71, 0xffff0000, v44
    v_and_b32 v72, 0xffff, v45
    v_lshlrev_b32 v73, 16, v45
    v_lshrrev_b32 v74, 16, v45
    v_and_b32 v75, 0xffff0000, v45
    v_and_b32 v76, 0xffff, v46
    v_lshlrev_b32 v77, 16, v46
    v_lshrrev_b32 v78, 16, v46
    v_and_b32 v79, 0xffff0000, v46
    v_and_b32 v80, 0xffff, v47
    v_lshlrev_b32 v81, 16, v47
    v_lshrrev_b32 v82, 16, v47
    v_and_b32 v83, 0xffff0000, v47
    v_dot2c_f32_bf16 v84, v96, v68
    v_dot2c_f32_bf16 v85, v96, v69
    v_dot2c_f32_bf16 v86, v97, v68
    v_dot2c_f32_bf16 v87, v97, v69
    v_dot2c_f32_bf16 v88, v98, v68
    v_dot2c_f32_bf16 v89, v98, v69
    v_dot2c_f32_bf16 v90, v99, v68
    v_dot2c_f32_bf16 v91, v99, v69
    s_waitcnt vmcnt(29)
    v_dot2c_f32_bf16 v84, v100, v70
    v_dot2c_f32_bf16 v85, v100, v71
    v_dot2c_f32_bf16 v86, v101, v70
    v_dot2c_f32_bf16 v87, v101, v71
    v_dot2c_f32_bf16 v88, v102, v70
    v_dot2c_f32_bf16 v89, v102, v71
    v_dot2c_f32_bf16 v90, v103, v70
    v_dot2c_f32_bf16 v91, v103, v71
    s_waitcnt vmcnt(28)
    v_dot2c_f32_bf16 v84, v104, v72
    v_dot2c_f32_bf16 v85, v104, v73
    v_dot2c_f32_bf16 v86, v105, v72
    v_dot2c_f32_bf16 v87, v105, v73
    v_dot2c_f32_bf16 v88, v106, v72
    v_dot2c_f32_bf16 v89, v106, v73
    v_dot2c_f32_bf16 v90, v107, v72
    v_dot2c_f32_bf16 v91, v107, v73
    s_waitcnt vmcnt(27)
    v_dot2c_f32_bf16 v84, v108, v74
    v_dot2c_f32_bf16 v85, v108, v75
    v_dot2c_f32_bf16 v86, v109, v74
    v_dot2c_f32_bf16 v87, v109, v75
    v_dot2c_f32_bf16 v88, v110, v74
    v_dot2c_f32_bf16 v89, v110, v75
    v_dot2c_f32_bf16 v90, v111, v74
    v_dot2c_f32_bf16 v91, v111, v75
    s_waitcnt vmcnt(26)
    v_dot2c_f32_bf16 v84, v112, v76
    v_dot2c_f32_bf16 v85, v112, v77
    v_dot2c_f32_bf16 v86, v113, v76
    v_dot2c_f32_bf16 v87, v113, v77
    v_dot2c_f32_bf16 v88, v114, v76
    v_dot2c_f32_bf16 v89, v114, v77
    v_dot2c_f32_bf16 v90, v115, v76
    v_dot2c_f32_bf16 v91, v115, v77
    s_waitcnt vmcnt(25)
    v_dot2c_f32_bf16 v84, v116, v78
    v_dot2c_f32_bf16 v85, v116, v79
    v_dot2c_f32_bf16 v86, v117, v78
    v_dot2c_f32_bf16 v87, v117, v79
    v_dot2c_f32_bf16 v88, v118, v78
    v_dot2c_f32_bf16 v89, v118, v79
    v_dot2c_f32_bf16 v90, v119, v78
    v_dot2c_f32_bf16 v91, v119, v79
    s_waitcnt vmcnt(24)
    v_dot2c_f32_bf16 v84, v120, v80
    v_dot2c_f32_bf16 v85, v120, v81
    v_dot2c_f32_bf16 v86, v121, v80
    v_dot2c_f32_bf16 v87, v121, v81
    v_dot2c_f32_bf16 v88, v122, v80
    v_dot2c_f32_bf16 v89, v122, v81
    v_dot2c_f32_bf16 v90, v123, v80
    v_dot2c_f32_bf16 v91, v123, v81
    s_waitcnt vmcnt(23)
    v_dot2c_f32_bf16 v84, v124, v82
    v_dot2c_f32_bf16 v85, v124, v83
    v_dot2c_f32_bf16 v86, v125, v82
    v_dot2c_f32_bf16 v87, v125, v83
    v_dot2c_f32_bf16 v88, v126, v82
    v_dot2c_f32_bf16 v89, v126, v83
    v_dot2c_f32_bf16 v90, v127, v82
    v_dot2c_f32_bf16 v91, v127, v83
    s_waitcnt vmcnt(22)
    v_and_b32 v68, 0xffff, v48
    v_lshlrev_b32 v69, 16, v48
    v_lshrrev_b32 v70, 16, v48
    v_and_b32 v71, 0xffff0000, v48
    v_and_b32 v72, 0xffff, v49
    v_lshlrev_b32 v73, 16, v49
    v_lshrrev_b32 v74, 16, v49
    v_and_b32 v75, 0xffff0000, v49
    v_and_b32 v76, 0xffff, v50
    v_lshlrev_b32 v77, 16, v50
    v_lshrrev_b32 v78, 16, v50
    v_and_b32 v79, 0xffff0000, v50
    v_and_b32 v80, 0xffff, v51
    v_lshlrev_b32 v81, 16, v51
    v_lshrrev_b32 v82, 16, v51
    v_and_b32 v83, 0xffff0000, v51
    v_dot2c_f32_bf16 v84, v128, v68
    v_dot2c_f32_bf16 v85, v128, v69
    v_dot2c_f32_bf16 v86, v129, v68
    v_dot2c_f32_bf16 v87, v129, v69
    v_dot2c_f32_bf16 v88, v130, v68
    v_dot2c_f32_bf16 v89, v130, v69
    v_dot2c_f32_bf16 v90, v131, v68
    v_dot2c_f32_bf16 v91, v131, v69
    s_waitcnt vmcnt(21)
    v_dot2c_f32_bf16 v84, v132, v70
    v_dot2c_f32_bf16 v85, v132, v71
    v_dot2c_f32_bf16 v86, v133, v70
    v_dot2c_f32_bf16 v87, v133, v71
    v_dot2c_f32_bf16 v88, v134, v70
    v_dot2c_f32_bf16 v89, v134, v71
    v_dot2c_f32_bf16 v90, v135, v70
    v_dot2c_f32_bf16 v91, v135, v71
    s_waitcnt vmcnt(20)
    v_dot2c_f32_bf16 v84, v136, v72
    v_dot2c_f32_bf16 v85, v136, v73
    v_dot2c_f32_bf16 v86, v137, v72
    v_dot2c_f32_bf16 v87, v137, v73
    v_dot2c_f32_bf16 v88, v138, v72
    v_dot2c_f32_bf16 v89, v138, v73
    v_dot2c_f32_bf16 v90, v139, v72
    v_dot2c_f32_bf16 v91, v139, v73
    s_waitcnt vmcnt(19)
    v_dot2c_f32_bf16 v84, v140, v74
    v_dot2c_f32_bf16 v85, v140, v75
    v_dot2c_f32_bf16 v86, v141, v74
    v_dot2c_f32_bf16 v87, v141, v75
    v_dot2c_f32_bf16 v88, v142, v74
    v_dot2c_f32_bf16 v89, v142, v75
    v_dot2c_f32_bf16 v90, v143, v74
    v_dot2c_f32_bf16 v91, v143, v75
    s_waitcnt vmcnt(18)
    v_dot2c_f32_bf16 v84, v144, v76
    v_dot2c_f32_bf16 v85, v144, v77
    v_dot2c_f32_bf16 v86, v145, v76
    v_dot2c_f32_bf16 v87, v145, v77
    v_dot2c_f32_bf16 v88, v146, v76
    v_dot2c_f32_bf16 v89, v146, v77
    v_dot2c_f32_bf16 v90, v147, v76
    v_dot2c_f32_bf16 v91, v147, v77
    s_waitcnt vmcnt(17)
    v_dot2c_f32_bf16 v84, v148, v78
    v_dot2c_f32_bf16 v85, v148, v79
    v_dot2c_f32_bf16 v86, v149, v78
    v_dot2c_f32_bf16 v87, v149, v79
    v_dot2c_f32_bf16 v88, v150, v78
    v_dot2c_f32_bf16 v89, v150, v79
    v_dot2c_f32_bf16 v90, v151, v78
    v_dot2c_f32_bf16 v91, v151, v79
    s_waitcnt vmcnt(16)
    v_dot2c_f32_bf16 v84, v152, v80
    v_dot2c_f32_bf16 v85, v152, v81
    v_dot2c_f32_bf16 v86, v153, v80
    v_dot2c_f32_bf16 v87, v153, v81
    v_dot2c_f32_bf16 v88, v154, v80
    v_dot2c_f32_bf16 v89, v154, v81
    v_dot2c_f32_bf16 v90, v155, v80
    v_dot2c_f32_bf16 v91, v155, v81
    s_waitcnt vmcnt(15)
    v_dot2c_f32_bf16 v84, v156, v82
    v_dot2c_f32_bf16 v85, v156, v83
    v_dot2c_f32_bf16 v86, v157, v82
    v_dot2c_f32_bf16 v87, v157, v83
    v_dot2c_f32_bf16 v88, v158, v82
    v_dot2c_f32_bf16 v89, v158, v83
    v_dot2c_f32_bf16 v90, v159, v82
    v_dot2c_f32_bf16 v91, v159, v83
    s_branch L_gtmid_27
L_gt_25:
    buffer_load_dwordx4 v[192:195], v66, s[44:47], s84 offen offset:0 sc1
    buffer_load_dwordx4 v[196:199], v66, s[44:47], s84 offen offset:512 sc1
    buffer_load_dwordx4 v[200:203], v66, s[44:47], s84 offen offset:1024 sc1
    buffer_load_dwordx4 v[204:207], v66, s[44:47], s85 offen offset:0 sc1
    buffer_load_dwordx4 v[208:211], v66, s[44:47], s85 offen offset:512 sc1
    buffer_load_dwordx4 v[212:215], v66, s[44:47], s85 offen offset:1024 sc1
    buffer_load_dwordx4 v[216:219], v66, s[44:47], s86 offen offset:0 sc1
    buffer_load_dwordx4 v[220:223], v66, s[44:47], s86 offen offset:512 sc1
    buffer_load_dwordx4 v[224:227], v66, s[44:47], s86 offen offset:1024 sc1
    buffer_load_dwordx4 v[228:231], v66, s[44:47], s87 offen offset:0 sc1
    buffer_load_dwordx4 v[232:235], v66, s[44:47], s87 offen offset:512 sc1
    buffer_load_dwordx4 v[236:239], v66, s[44:47], s87 offen offset:1024 sc1
    buffer_load_dwordx4 v[240:243], v66, s[44:47], s88 offen offset:0 sc1
    buffer_load_dwordx4 v[244:247], v66, s[44:47], s88 offen offset:512 sc1
    buffer_load_dwordx4 v[248:251], v66, s[44:47], s88 offen offset:1024 sc1
L_gtmid_27:
    v_mov_b32 v4, 0
    v_mov_b32 v5, 0
    s_waitcnt vmcnt(0)
    v_bitop3_b32 v4, v4, v193, s60 bitop3:0xf6
    v_bitop3_b32 v4, v4, v195, s60 bitop3:0xf6
    v_bitop3_b32 v4, v4, v197, s60 bitop3:0xf6
    v_bitop3_b32 v4, v4, v199, s60 bitop3:0xf6
    v_bitop3_b32 v4, v4, v201, s60 bitop3:0xf6
    v_bitop3_b32 v4, v4, v203, s60 bitop3:0xf6
    v_bitop3_b32 v4, v4, v205, s60 bitop3:0xf6
    v_bitop3_b32 v4, v4, v207, s60 bitop3:0xf6
    v_bitop3_b32 v4, v4, v209, s60 bitop3:0xf6
    v_bitop3_b32 v4, v4, v211, s60 bitop3:0xf6
    v_bitop3_b32 v4, v4, v213, s60 bitop3:0xf6
    v_bitop3_b32 v4, v4, v215, s60 bitop3:0xf6
    v_bitop3_b32 v4, v4, v217, s60 bitop3:0xf6
    v_bitop3_b32 v4, v4, v219, s60 bitop3:0xf6
    v_bitop3_b32 v4, v4, v221, s60 bitop3:0xf6
    v_bitop3_b32 v4, v4, v223, s60 bitop3:0xf6
    v_bitop3_b32 v4, v4, v225, s60 bitop3:0xf6
    v_bitop3_b32 v4, v4, v227, s60 bitop3:0xf6
    v_bitop3_b32 v4, v4, v229, s60 bitop3:0xf6
    v_bitop3_b32 v4, v4, v231, s60 bitop3:0xf6
    v_bitop3_b32 v4, v4, v233, s60 bitop3:0xf6
    v_bitop3_b32 v4, v4, v235, s60 bitop3:0xf6
    v_bitop3_b32 v4, v4, v237, s60 bitop3:0xf6
    v_bitop3_b32 v4, v4, v239, s60 bitop3:0xf6
    v_bitop3_b32 v4, v4, v241, s60 bitop3:0xf6
    v_bitop3_b32 v4, v4, v243, s60 bitop3:0xf6
    v_bitop3_b32 v4, v4, v245, s60 bitop3:0xf6
    v_bitop3_b32 v4, v4, v247, s60 bitop3:0xf6
    v_bitop3_b32 v4, v4, v249, s60 bitop3:0xf6
    v_bitop3_b32 v4, v4, v251, s60 bitop3:0xf6
    v_cmp_ne_u32 vcc, 0, v4
    s_nop 4
    s_cbranch_vccz L_gtok_26
    s_sleep 4
    s_sub_u32 s62, s62, 1
    s_cmp_lg_u32 s62, 0
    s_cbranch_scc1 L_gt_25
    s_endpgm
L_gtok_26:
    v_add_f32 v192, v192, v204
    v_add_f32 v194, v194, v206
    v_add_f32 v196, v196, v208
    v_add_f32 v198, v198, v210
    v_add_f32 v200, v200, v212
    v_add_f32 v202, v202, v214
    v_add_f32 v192, v192, v216
    v_add_f32 v194, v194, v218
    v_add_f32 v196, v196, v220
    v_add_f32 v198, v198, v222
    v_add_f32 v200, v200, v224
    v_add_f32 v202, v202, v226
    v_add_f32 v192, v192, v228
    v_add_f32 v194, v194, v230
    v_add_f32 v196, v196, v232
    v_add_f32 v198, v198, v234
    v_add_f32 v200, v200, v236
    v_add_f32 v202, v202, v238
    v_add_f32 v192, v192, v240
    v_add_f32 v194, v194, v242
    v_add_f32 v196, v196, v244
    v_add_f32 v198, v198, v246
    v_add_f32 v200, v200, v248
    v_add_f32 v202, v202, v250
    v_mov_b32 v193, v192
    v_mov_b32 v195, v194
    v_mov_b32 v197, v196
    v_mov_b32 v199, v198
    v_mov_b32 v201, v200
    v_mov_b32 v203, v202
    s_nop 0
    v_permlane32_swap_b32 v192, v193
    v_permlane32_swap_b32 v194, v195
    v_permlane32_swap_b32 v196, v197
    v_permlane32_swap_b32 v198, v199
    v_permlane32_swap_b32 v200, v201
    v_permlane32_swap_b32 v202, v203
    v_add_f32 v192, v192, v193
    v_add_f32 v194, v194, v195
    v_add_f32 v196, v196, v197
    v_add_f32 v198, v198, v199
    v_add_f32 v200, v200, v201
    v_add_f32 v202, v202, v203
    v_cvt_pk_bf16_f32 v192, v192, v194
    ds_write_b32 v9, v192 offset:64
    v_cvt_pk_bf16_f32 v196, v196, v198
    ds_write_b32 v9, v196 offset:192
    v_cvt_pk_bf16_f32 v200, v200, v202
    ds_write_b32 v9, v200 offset:320
    s_waitcnt lgkmcnt(0)
    v_mov_b32 v4, 16
    v_mov_b32 v5, 1
    ds_write_b32 v4, v5
    s_setprio 0
    s_nop 2
    v_permlane32_swap_b32 v84, v88
    v_permlane32_swap_b32 v85, v89
    v_permlane32_swap_b32 v86, v90
    v_permlane32_swap_b32 v87, v91
    s_nop 0
    v_add_f32 v84, v84, v88
    v_add_f32 v85, v85, v89
    v_add_f32 v86, v86, v90
    v_add_f32 v87, v87, v91
    s_nop 1
    v_permlane16_swap_b32 v84, v86
    v_permlane16_swap_b32 v85, v87
    s_nop 0
    v_add_f32 v84, v84, v86
    v_add_f32 v85, v85, v87
    s_nop 1
    v_add_f32_dpp v92, v84, v84 row_ror:8 row_mask:0xf bank_mask:0xf
    v_add_f32_dpp v94, v85, v85 row_ror:8 row_mask:0xf bank_mask:0xf
    s_mul_i32 s6, s53, 7680
    s_lshl_b32 s7, s52, 9
    s_add_u32 s6, s6, s7
    s_add_u32 s6, s6, s58
    s_add_u32 s6, s6, 131072
    s_cmp_lt_u32 s5, 30
    s_cselect_b32 s6, s6, 4194304
    s_mov_b32 exec_lo, 0x00ff00ff
    s_mov_b32 exec_hi, 0x00ff00ff
    buffer_store_dwordx4 v[92:95], v18, s[44:47], s6 offen sc1
    s_mov_b64 exec, -1
    s_mov_b32 s62, 4000000
    v_mov_b32 v8, 0
L_wl_28:
    ds_read_b64 v[4:5], v8 offset:8
    s_waitcnt lgkmcnt(0)
    v_min_u32 v4, v4, v5
    s_nop 0
    v_readfirstlane_b32 s63, v4
    s_cmp_ge_u32 s63, 3
    s_cbranch_scc1 L_wlok_29
    s_sleep 8
    s_sub_u32 s62, s62, 1
    s_cmp_lg_u32 s62, 0
    s_cbranch_scc1 L_wl_28
    s_endpgm
L_wlok_29:
    s_add_u32 s6, s58, 131072
    s_add_u32 s7, s6, 4096
    s_mov_b32 s62, 400000
L_gt_30:
    buffer_load_dwordx4 v[192:195], v67, s[44:47], s6 offen offset:0 sc1
    buffer_load_dwordx4 v[196:199], v67, s[44:47], s6 offen offset:512 sc1
    buffer_load_dwordx4 v[200:203], v67, s[44:47], s6 offen offset:1024 sc1
    buffer_load_dwordx4 v[204:207], v67, s[44:47], s6 offen offset:1536 sc1
    buffer_load_dwordx4 v[208:211], v67, s[44:47], s6 offen offset:2048 sc1
    buffer_load_dwordx4 v[212:215], v67, s[44:47], s6 offen offset:2560 sc1
    buffer_load_dwordx4 v[216:219], v67, s[44:47], s6 offen offset:3072 sc1
    buffer_load_dwordx4 v[220:223], v67, s[44:47], s6 offen offset:3584 sc1
    buffer_load_dwordx4 v[224:227], v67, s[44:47], s7 offen offset:0 sc1
L_gtmid_32:
    v_mov_b32 v4, 0
    v_mov_b32 v5, 0
    s_waitcnt vmcnt(0)
    v_bitop3_b32 v4, v4, v193, s60 bitop3:0xf6
    v_bitop3_b32 v4, v4, v195, s60 bitop3:0xf6
    v_bitop3_b32 v4, v4, v197, s60 bitop3:0xf6
    v_bitop3_b32 v4, v4, v199, s60 bitop3:0xf6
    v_bitop3_b32 v4, v4, v201, s60 bitop3:0xf6
    v_bitop3_b32 v4, v4, v203, s60 bitop3:0xf6
    v_bitop3_b32 v4, v4, v205, s60 bitop3:0xf6
    v_bitop3_b32 v4, v4, v207, s60 bitop3:0xf6
    v_bitop3_b32 v4, v4, v209, s60 bitop3:0xf6
    v_bitop3_b32 v4, v4, v211, s60 bitop3:0xf6
    v_bitop3_b32 v4, v4, v213, s60 bitop3:0xf6
    v_bitop3_b32 v4, v4, v215, s60 bitop3:0xf6
    v_bitop3_b32 v4, v4, v217, s60 bitop3:0xf6
    v_bitop3_b32 v4, v4, v219, s60 bitop3:0xf6
    v_bitop3_b32 v4, v4, v221, s60 bitop3:0xf6
    v_bitop3_b32 v4, v4, v223, s60 bitop3:0xf6
    v_bitop3_b32 v4, v4, v225, s60 bitop3:0xf6
    v_bitop3_b32 v4, v4, v227, s60 bitop3:0xf6
    v_cmp_ne_u32 vcc, 0, v4
    s_nop 4
    s_cbranch_vccz L_gtok_31
    s_sleep 32
    s_sub_u32 s62, s62, 1
    s_cmp_lg_u32 s62, 0
    s_cbranch_scc1 L_gt_30
    s_endpgm
L_gtok_31:
    v_mov_b32 v193, v192
    v_mov_b32 v195, v194
    v_mov_b32 v197, v196
    v_mov_b32 v199, v198
    v_mov_b32 v201, v200
    v_mov_b32 v203, v202
    v_mov_b32 v205, v204
    v_mov_b32 v207, v206
    v_mov_b32 v209, v208
    v_mov_b32 v211, v210
    v_mov_b32 v213, v212
    v_mov_b32 v215, v214
    v_mov_b32 v217, v216
    v_mov_b32 v219, v218
    v_mov_b32 v221, v220
    v_mov_b32 v223, v222
    v_mov_b32 v225, v224
    v_mov_b32 v227, v226
    s_nop 0
    v_permlane32_swap_b32 v192, v193
    v_permlane32_swap_b32 v194, v195
    v_permlane32_swap_b32 v196, v197
    v_permlane32_swap_b32 v198, v199
    v_permlane32_swap_b32 v200, v201
    v_permlane32_swap_b32 v202, v203
    v_permlane32_swap_b32 v204, v205
    v_permlane32_swap_b32 v206, v207
    v_permlane32_swap_b32 v208, v209
    v_permlane32_swap_b32 v210, v211
    v_permlane32_swap_b32 v212, v213
    v_permlane32_swap_b32 v214, v215
    v_permlane32_swap_b32 v216, v217
    v_permlane32_swap_b32 v218, v219
    v_permlane32_swap_b32 v220, v221
    v_permlane32_swap_b32 v222, v223
    v_permlane32_swap_b32 v224, v225
    v_permlane32_swap_b32 v226, v227
    v_add_f32 v192, v192, v193
    v_add_f32 v194, v194, v195
    v_add_f32 v196, v196, v197
    v_add_f32 v198, v198, v199
    v_add_f32 v200, v200, v201
    v_add_f32 v202, v202, v203
    v_add_f32 v204, v204, v205
    v_add_f32 v206, v206, v207
    v_add_f32 v208, v208, v209
    v_add_f32 v210, v210, v211
    v_add_f32 v212, v212, v213
    v_add_f32 v214, v214, v215
    v_add_f32 v216, v216, v217
    v_add_f32 v218, v218, v219
    v_add_f32 v220, v220, v221
    v_add_f32 v222, v222, v223
    v_add_f32 v224, v224, v225
    v_add_f32 v226, v226, v227
    v_cvt_pk_bf16_f32 v192, v192, v194
    ds_write_b32 v9, v192 offset:448
    v_cvt_pk_bf16_f32 v196, v196, v198
    ds_write_b32 v9, v196 offset:576
    v_cvt_pk_bf16_f32 v200, v200, v202
    ds_write_b32 v9, v200 offset:704
    v_cvt_pk_bf16_f32 v204, v204, v206
    v_cvt_pk_bf16_f32 v208, v208, v210
    v_cvt_pk_bf16_f32 v212, v212, v214
    v_cvt_pk_bf16_f32 v216, v216, v218
    ds_write_b32 v9, v216 offset:3904
    v_cvt_pk_bf16_f32 v220, v220, v222
    ds_write_b32 v9, v220 offset:4032
    v_cvt_pk_bf16_f32 v224, v224, v226
    ds_write_b32 v9, v224 offset:4160
    s_waitcnt lgkmcnt(0)
    v_mov_b32 v4, 16
    v_mov_b32 v5, 2
    ds_write_b32 v4, v5
    v_mov_b32 v92, v204
    v_mov_b32 v93, v208
    v_mov_b32 v94, v212
    v_mov_b32 v95, s60
    s_lshl_b32 s6, s4, 9
    s_add_u32 s6, s6, 516096
    s_cmp_eq_u32 s5, 31
    s_cselect_b32 s6, s6, 4194304
    s_mov_b32 exec_hi, 0
    buffer_store_dwordx4 v[92:95], v19, s[44:47], s6 offen sc1
    s_mov_b64 exec, -1
    s_mov_b32 s62, 4000000
    v_mov_b32 v8, 0
L_wl_33:
    ds_read_b64 v[4:5], v8 offset:8
    s_waitcnt lgkmcnt(0)
    v_min_u32 v4, v4, v5
    s_nop 0
    v_readfirstlane_b32 s63, v4
    s_cmp_ge_u32 s63, 9
    s_cbranch_scc1 L_wlok_34
    s_sleep 8
    s_sub_u32 s62, s62, 1
    s_cmp_lg_u32 s62, 0
    s_cbranch_scc1 L_wl_33
    s_endpgm
L_wlok_34:
    s_mov_b32 s6, 516096
    s_mov_b32 s62, 400000
L_gt_35:
    buffer_load_dwordx4 v[192:195], v19, s[44:47], s6 offen offset:0 sc1
    buffer_load_dwordx4 v[196:199], v19, s[44:47], s6 offen offset:1024 sc1
    buffer_load_dwordx4 v[200:203], v19, s[44:47], s6 offen offset:2048 sc1
    buffer_load_dwordx4 v[204:207], v19, s[44:47], s6 offen offset:3072 sc1
L_gtmid_37:
    v_mov_b32 v4, 0
    v_mov_b32 v5, 0
    s_waitcnt vmcnt(0)
    v_bitop3_b32 v4, v4, v195, s60 bitop3:0xf6
    v_bitop3_b32 v4, v4, v199, s60 bitop3:0xf6
    v_bitop3_b32 v4, v4, v203, s60 bitop3:0xf6
    v_bitop3_b32 v4, v4, v207, s60 bitop3:0xf6
    v_cmp_ne_u32 vcc, 0, v4
    s_nop 4
    s_cbranch_vccz L_gtok_36
    s_sleep 32
    s_sub_u32 s62, s62, 1
    s_cmp_lg_u32 s62, 0
    s_cbranch_scc1 L_gt_35
    s_endpgm
L_gtok_36:
    v_lshrrev_b32 v11, 5, v0
    v_mul_u32_u24 v11, 384, v11
    v_add_u32 v11, v11, v9
    ds_write_b32 v11, v192 offset:832
    ds_write_b32 v11, v193 offset:960
    ds_write_b32 v11, v194 offset:1088
    ds_write_b32 v11, v196 offset:1600
    ds_write_b32 v11, v197 offset:1728
    ds_write_b32 v11, v198 offset:1856
    ds_write_b32 v11, v200 offset:2368
    ds_write_b32 v11, v201 offset:2496
    ds_write_b32 v11, v202 offset:2624
    ds_write_b32 v11, v204 offset:3136
    ds_write_b32 v11, v205 offset:3264
    ds_write_b32 v11, v206 offset:3392
    s_waitcnt lgkmcnt(0)
    v_mov_b32 v4, 16
    v_mov_b32 v5, 3
    ds_write_b32 v4, v5
    s_movk_i32 s61, 0xff
    v_bfe_u32 v14, s60, 0, 8
    v_bfe_u32 v15, s60, 8, 8
    v_bfe_u32 v16, s60, 16, 8
    v_bfe_u32 v17, s60, 24, 8
    s_getreg_b32 s59, hwreg(HW_REG_XCC_ID, 0, 4)
    v_mov_b32 v160, s59
    v_mov_b32 v162, s59
    s_mov_b32 s62, 4000000
    v_mov_b32 v8, 0
L_wl_38:
    ds_read_b64 v[4:5], v8 offset:8
    s_waitcnt lgkmcnt(0)
    v_min_u32 v4, v4, v5
    s_nop 0
    v_readfirstlane_b32 s63, v4
    s_cmp_ge_u32 s63, 8
    s_cbranch_scc1 L_wlok_39
    s_sleep 8
    s_sub_u32 s62, s62, 1
    s_cmp_lg_u32 s62, 0
    s_cbranch_scc1 L_wl_38
    s_endpgm
L_wlok_39:
    v_lshlrev_b32 v22, 5, v0
    ds_read_b128 v[128:131], v22 offset:5632
    ds_read_b128 v[132:135], v22 offset:5648
    s_waitcnt lgkmcnt(0)
    v_lshlrev_b32 v24, 16, v128
    v_and_b32 v25, 0xffff0000, v128
    v_lshlrev_b32 v26, 16, v129
    v_and_b32 v27, 0xffff0000, v129
    v_lshlrev_b32 v28, 16, v130
    v_and_b32 v29, 0xffff0000, v130
    v_lshlrev_b32 v30, 16, v131
    v_and_b32 v31, 0xffff0000, v131
    v_lshlrev_b32 v32, 16, v132
    v_and_b32 v33, 0xffff0000, v132
    v_lshlrev_b32 v34, 16, v133
    v_and_b32 v35, 0xffff0000, v133
    v_lshlrev_b32 v36, 16, v134
    v_and_b32 v37, 0xffff0000, v134
    v_lshlrev_b32 v38, 16, v135
    v_and_b32 v39, 0xffff0000, v135
    v_mul_f32 v24, 0x3d93cd3a, v24
    v_mul_f32 v25, 0x3d93cd3a, v25
    v_mul_f32 v26, 0x3d93cd3a, v26
    v_mul_f32 v27, 0x3d93cd3a, v27
    v_mul_f32 v28, 0x3d93cd3a, v28
    v_mul_f32 v29, 0x3d93cd3a, v29
    v_mul_f32 v30, 0x3d93cd3a, v30
    v_mul_f32 v31, 0x3d93cd3a, v31
    v_mul_f32 v32, 0x3d93cd3a, v32
    v_mul_f32 v33, 0x3d93cd3a, v33
    v_mul_f32 v34, 0x3d93cd3a, v34
    v_mul_f32 v35, 0x3d93cd3a, v35
    v_mul_f32 v36, 0x3d93cd3a, v36
    v_mul_f32 v37, 0x3d93cd3a, v37
    v_mul_f32 v38, 0x3d93cd3a, v38
    v_mul_f32 v39, 0x3d93cd3a, v39
    v_cvt_pk_bf16_f32 v128, v24, v25
    v_cvt_pk_bf16_f32 v129, v26, v27
    v_cvt_pk_bf16_f32 v130, v28, v29
    v_cvt_pk_bf16_f32 v131, v30, v31
    v_cvt_pk_bf16_f32 v132, v32, v33
    v_cvt_pk_bf16_f32 v133, v34, v35
    v_cvt_pk_bf16_f32 v134, v36, v37
    v_cvt_pk_bf16_f32 v135, v38, v39
    v_lshlrev_b32 v24, 16, v128
    v_and_b32 v25, 0xffff0000, v128
    v_lshlrev_b32 v26, 16, v129
    v_and_b32 v27, 0xffff0000, v129
    v_lshlrev_b32 v28, 16, v130
    v_and_b32 v29, 0xffff0000, v130
    v_lshlrev_b32 v30, 16, v131
    v_and_b32 v31, 0xffff0000, v131
    v_lshlrev_b32 v32, 16, v132
    v_and_b32 v33, 0xffff0000, v132
    v_lshlrev_b32 v34, 16, v133
    v_and_b32 v35, 0xffff0000, v133
    v_lshlrev_b32 v36, 16, v134
    v_and_b32 v37, 0xffff0000, v134
    v_lshlrev_b32 v38, 16, v135
    v_and_b32 v39, 0xffff0000, v135
    v_max_f32 v20, v24, v25
    v_max3_f32 v20, v20, v26, v27
    v_max3_f32 v20, v20, v28, v29
    v_max3_f32 v20, v20, v30, v31
    v_max3_f32 v20, v20, v32, v33
    v_max3_f32 v20, v20, v34, v35
    v_max3_f32 v20, v20, v36, v37
    v_max3_f32 v20, v20, v38, v39
    s_nop 1
    v_max_f32_dpp v20, v20, v20 quad_perm:[1,0,3,2] row_mask:0xf bank_mask:0xf
    s_nop 1
    v_max_f32_dpp v20, v20, v20 quad_perm:[2,3,0,1] row_mask:0xf bank_mask:0xf
    s_nop 1
    v_max_f32_dpp v20, v20, v20 row_half_mirror row_mask:0xf bank_mask:0xf
    s_nop 1
    v_max_f32_dpp v20, v20, v20 row_mirror row_mask:0xf bank_mask:0xf
    v_mov_b32 v10, v20
    s_nop 1
    v_permlane16_swap_b32 v20, v10
    s_nop 1
    v_max_f32 v20, v20, v10
    v_mov_b32 v10, v20
    s_nop 1
    v_permlane32_swap_b32 v20, v10
    s_nop 1
    v_max_f32 v20, v20, v10
    v_sub_f32 v24, v24, v20
    v_sub_f32 v25, v25, v20
    v_sub_f32 v26, v26, v20
    v_sub_f32 v27, v27, v20
    v_sub_f32 v28, v28, v20
    v_sub_f32 v29, v29, v20
    v_sub_f32 v30, v30, v20
    v_sub_f32 v31, v31, v20
    v_sub_f32 v32, v32, v20
    v_sub_f32 v33, v33, v20
    v_sub_f32 v34, v34, v20
    v_sub_f32 v35, v35, v20
    v_sub_f32 v36, v36, v20
    v_sub_f32 v37, v37, v20
    v_sub_f32 v38, v38, v20
    v_sub_f32 v39, v39, v20
    v_mul_f32 v24, 0x3fb8aa3b, v24
    v_mul_f32 v25, 0x3fb8aa3b, v25
    v_mul_f32 v26, 0x3fb8aa3b, v26
    v_mul_f32 v27, 0x3fb8aa3b, v27
    v_mul_f32 v28, 0x3fb8aa3b, v28
    v_mul_f32 v29, 0x3fb8aa3b, v29
    v_mul_f32 v30, 0x3fb8aa3b, v30
    v_mul_f32 v31, 0x3fb8aa3b, v31
    v_mul_f32 v32, 0x3fb8aa3b, v32
    v_mul_f32 v33, 0x3fb8aa3b, v33
    v_mul_f32 v34, 0x3fb8aa3b, v34
    v_mul_f32 v35, 0x3fb8aa3b, v35
    v_mul_f32 v36, 0x3fb8aa3b, v36
    v_mul_f32 v37, 0x3fb8aa3b, v37
    v_mul_f32 v38, 0x3fb8aa3b, v38
    v_mul_f32 v39, 0x3fb8aa3b, v39
    v_exp_f32 v24, v24
    v_exp_f32 v25, v25
    v_exp_f32 v26, v26
    v_exp_f32 v27, v27
    v_exp_f32 v28, v28
    v_exp_f32 v29, v29
    v_exp_f32 v30, v30
    v_exp_f32 v31, v31
    v_exp_f32 v32, v32
    v_exp_f32 v33, v33
    v_exp_f32 v34, v34
    v_exp_f32 v35, v35
    v_exp_f32 v36, v36
    v_exp_f32 v37, v37
    v_exp_f32 v38, v38
    v_exp_f32 v39, v39
    s_nop 0
    v_add_f32 v21, v24, v25
    v_add_f32 v21, v21, v26
    v_add_f32 v21, v21, v27
    v_add_f32 v21, v21, v28
    v_add_f32 v21, v21, v29
    v_add_f32 v21, v21, v30
    v_add_f32 v21, v21, v31
    v_add_f32 v21, v21, v32
    v_add_f32 v21, v21, v33
    v_add_f32 v21, v21, v34
    v_add_f32 v21, v21, v35
    v_add_f32 v21, v21, v36
    v_add_f32 v21, v21, v37
    v_add_f32 v21, v21, v38
    v_add_f32 v21, v21, v39
    s_nop 1
    v_add_f32_dpp v21, v21, v21 quad_perm:[1,0,3,2] row_mask:0xf bank_mask:0xf
    s_nop 1
    v_add_f32_dpp v21, v21, v21 quad_perm:[2,3,0,1] row_mask:0xf bank_mask:0xf
    s_nop 1
    v_add_f32_dpp v21, v21, v21 row_half_mirror row_mask:0xf bank_mask:0xf
    s_nop 1
    v_add_f32_dpp v21, v21, v21 row_mirror row_mask:0xf bank_mask:0xf
    v_mov_b32 v10, v21
    s_nop 1
    v_permlane16_swap_b32 v21, v10
    s_nop 1
    v_add_f32 v21, v21, v10
    v_mov_b32 v10, v21
    s_nop 1
    v_permlane32_swap_b32 v21, v10
    s_nop 1
    v_add_f32 v21, v21, v10
    v_cmp_eq_u32 vcc, 0, v0
    s_nop 1
    v_cndmask_b32 v160, v160, v20, vcc
    v_cndmask_b32 v162, v162, v21, vcc
    s_mov_b32 s62, 4000000
    v_mov_b32 v8, 0
L_wl_40:
    ds_read_b64 v[4:5], v8 offset:8
    s_waitcnt lgkmcnt(0)
    v_min_u32 v4, v4, v5
    s_nop 0
    v_readfirstlane_b32 s63, v4
    s_cmp_ge_u32 s63, 16
    s_cbranch_scc1 L_wlok_41
    s_sleep 8
    s_sub_u32 s62, s62, 1
    s_cmp_lg_u32 s62, 0
    s_cbranch_scc1 L_wl_40
    s_endpgm
L_wlok_41:
    v_lshlrev_b32 v22, 5, v0
    ds_read_b128 v[136:139], v22 offset:7680
    ds_read_b128 v[140:143], v22 offset:7696
    s_waitcnt lgkmcnt(0)
    v_lshlrev_b32 v24, 16, v136
    v_and_b32 v25, 0xffff0000, v136
    v_lshlrev_b32 v26, 16, v137
    v_and_b32 v27, 0xffff0000, v137
    v_lshlrev_b32 v28, 16, v138
    v_and_b32 v29, 0xffff0000, v138
    v_lshlrev_b32 v30, 16, v139
    v_and_b32 v31, 0xffff0000, v139
    v_lshlrev_b32 v32, 16, v140
    v_and_b32 v33, 0xffff0000, v140
    v_lshlrev_b32 v34, 16, v141
    v_and_b32 v35, 0xffff0000, v141
    v_lshlrev_b32 v36, 16, v142
    v_and_b32 v37, 0xffff0000, v142
    v_lshlrev_b32 v38, 16, v143
    v_and_b32 v39, 0xffff0000, v143
    v_mul_f32 v24, 0x3d93cd3a, v24
    v_mul_f32 v25, 0x3d93cd3a, v25
    v_mul_f32 v26, 0x3d93cd3a, v26
    v_mul_f32 v27, 0x3d93cd3a, v27
    v_mul_f32 v28, 0x3d93cd3a, v28
    v_mul_f32 v29, 0x3d93cd3a, v29
    v_mul_f32 v30, 0x3d93cd3a, v30
    v_mul_f32 v31, 0x3d93cd3a, v31
    v_mul_f32 v32, 0x3d93cd3a, v32
    v_mul_f32 v33, 0x3d93cd3a, v33
    v_mul_f32 v34, 0x3d93cd3a, v34
    v_mul_f32 v35, 0x3d93cd3a, v35
    v_mul_f32 v36, 0x3d93cd3a, v36
    v_mul_f32 v37, 0x3d93cd3a, v37
    v_mul_f32 v38, 0x3d93cd3a, v38
    v_mul_f32 v39, 0x3d93cd3a, v39
    v_cvt_pk_bf16_f32 v136, v24, v25
    v_cvt_pk_bf16_f32 v137, v26, v27
    v_cvt_pk_bf16_f32 v138, v28, v29
    v_cvt_pk_bf16_f32 v139, v30, v31
    v_cvt_pk_bf16_f32 v140, v32, v33
    v_cvt_pk_bf16_f32 v141, v34, v35
    v_cvt_pk_bf16_f32 v142, v36, v37
    v_cvt_pk_bf16_f32 v143, v38, v39
    v_lshlrev_b32 v24, 16, v136
    v_and_b32 v25, 0xffff0000, v136
    v_lshlrev_b32 v26, 16, v137
    v_and_b32 v27, 0xffff0000, v137
    v_lshlrev_b32 v28, 16, v138
    v_and_b32 v29, 0xffff0000, v138
    v_lshlrev_b32 v30, 16, v139
    v_and_b32 v31, 0xffff0000, v139
    v_lshlrev_b32 v32, 16, v140
    v_and_b32 v33, 0xffff0000, v140
    v_lshlrev_b32 v34, 16, v141
    v_and_b32 v35, 0xffff0000, v141
    v_lshlrev_b32 v36, 16, v142
    v_and_b32 v37, 0xffff0000, v142
    v_lshlrev_b32 v38, 16, v143
    v_and_b32 v39, 0xffff0000, v143
    v_max_f32 v20, v24, v25
    v_max3_f32 v20, v20, v26, v27
    v_max3_f32 v20, v20, v28, v29
    v_max3_f32 v20, v20, v30, v31
    v_max3_f32 v20, v20, v32, v33
    v_max3_f32 v20, v20, v34, v35
    v_max3_f32 v20, v20, v36, v37
    v_max3_f32 v20, v20, v38, v39
    s_nop 1
    v_max_f32_dpp v20, v20, v20 quad_perm:[1,0,3,2] row_mask:0xf bank_mask:0xf
    s_nop 1
    v_max_f32_dpp v20, v20, v20 quad_perm:[2,3,0,1] row_mask:0xf bank_mask:0xf
    s_nop 1
    v_max_f32_dpp v20, v20, v20 row_half_mirror row_mask:0xf bank_mask:0xf
    s_nop 1
    v_max_f32_dpp v20, v20, v20 row_mirror row_mask:0xf bank_mask:0xf
    v_mov_b32 v10, v20
    s_nop 1
    v_permlane16_swap_b32 v20, v10
    s_nop 1
    v_max_f32 v20, v20, v10
    v_mov_b32 v10, v20
    s_nop 1
    v_permlane32_swap_b32 v20, v10
    s_nop 1
    v_max_f32 v20, v20, v10
    v_sub_f32 v24, v24, v20
    v_sub_f32 v25, v25, v20
    v_sub_f32 v26, v26, v20
    v_sub_f32 v27, v27, v20
    v_sub_f32 v28, v28, v20
    v_sub_f32 v29, v29, v20
    v_sub_f32 v30, v30, v20
    v_sub_f32 v31, v31, v20
    v_sub_f32 v32, v32, v20
    v_sub_f32 v33, v33, v20
    v_sub_f32 v34, v34, v20
    v_sub_f32 v35, v35, v20
    v_sub_f32 v36, v36, v20
    v_sub_f32 v37, v37, v20
    v_sub_f32 v38, v38, v20
    v_sub_f32 v39, v39, v20
    v_mul_f32 v24, 0x3fb8aa3b, v24
    v_mul_f32 v25, 0x3fb8aa3b, v25
    v_mul_f32 v26, 0x3fb8aa3b, v26
    v_mul_f32 v27, 0x3fb8aa3b, v27
    v_mul_f32 v28, 0x3fb8aa3b, v28
    v_mul_f32 v29, 0x3fb8aa3b, v29
    v_mul_f32 v30, 0x3fb8aa3b, v30
    v_mul_f32 v31, 0x3fb8aa3b, v31
    v_mul_f32 v32, 0x3fb8aa3b, v32
    v_mul_f32 v33, 0x3fb8aa3b, v33
    v_mul_f32 v34, 0x3fb8aa3b, v34
    v_mul_f32 v35, 0x3fb8aa3b, v35
    v_mul_f32 v36, 0x3fb8aa3b, v36
    v_mul_f32 v37, 0x3fb8aa3b, v37
    v_mul_f32 v38, 0x3fb8aa3b, v38
    v_mul_f32 v39, 0x3fb8aa3b, v39
    v_exp_f32 v24, v24
    v_exp_f32 v25, v25
    v_exp_f32 v26, v26
    v_exp_f32 v27, v27
    v_exp_f32 v28, v28
    v_exp_f32 v29, v29
    v_exp_f32 v30, v30
    v_exp_f32 v31, v31
    v_exp_f32 v32, v32
    v_exp_f32 v33, v33
    v_exp_f32 v34, v34
    v_exp_f32 v35, v35
    v_exp_f32 v36, v36
    v_exp_f32 v37, v37
    v_exp_f32 v38, v38
    v_exp_f32 v39, v39
    s_nop 0
    v_add_f32 v21, v24, v25
    v_add_f32 v21, v21, v26
    v_add_f32 v21, v21, v27
    v_add_f32 v21, v21, v28
    v_add_f32 v21, v21, v29
    v_add_f32 v21, v21, v30
    v_add_f32 v21, v21, v31
    v_add_f32 v21, v21, v32
    v_add_f32 v21, v21, v33
    v_add_f32 v21, v21, v34
    v_add_f32 v21, v21, v35
    v_add_f32 v21, v21, v36
    v_add_f32 v21, v21, v37
    v_add_f32 v21, v21, v38
    v_add_f32 v21, v21, v39
    s_nop 1
    v_add_f32_dpp v21, v21, v21 quad_perm:[1,0,3,2] row_mask:0xf bank_mask:0xf
    s_nop 1
    v_add_f32_dpp v21, v21, v21 quad_perm:[2,3,0,1] row_mask:0xf bank_mask:0xf
    s_nop 1
    v_add_f32_dpp v21, v21, v21 row_half_mirror row_mask:0xf bank_mask:0xf
    s_nop 1
    v_add_f32_dpp v21, v21, v21 row_mirror row_mask:0xf bank_mask:0xf
    v_mov_b32 v10, v21
    s_nop 1
    v_permlane16_swap_b32 v21, v10
    s_nop 1
    v_add_f32 v21, v21, v10
    v_mov_b32 v10, v21
    s_nop 1
    v_permlane32_swap_b32 v21, v10
    s_nop 1
    v_add_f32 v21, v21, v10
    v_cmp_eq_u32 vcc, 1, v0
    s_nop 1
    v_cndmask_b32 v160, v160, v20, vcc
    v_cndmask_b32 v162, v162, v21, vcc
    s_mov_b32 s62, 4000000
    v_mov_b32 v8, 0
L_wl_42:
    ds_read_b64 v[4:5], v8 offset:8
    s_waitcnt lgkmcnt(0)
    v_min_u32 v4, v4, v5
    s_nop 0
    v_readfirstlane_b32 s63, v4
    s_cmp_ge_u32 s63, 24
    s_cbranch_scc1 L_wlok_43
    s_sleep 8
    s_sub_u32 s62, s62, 1
    s_cmp_lg_u32 s62, 0
    s_cbranch_scc1 L_wl_42
    s_endpgm
L_wlok_43:
    v_lshlrev_b32 v22, 5, v0
    ds_read_b128 v[144:147], v22 offset:9728
    ds_read_b128 v[148:151], v22 offset:9744
    s_waitcnt lgkmcnt(0)
    v_lshlrev_b32 v24, 16, v144
    v_and_b32 v25, 0xffff0000, v144
    v_lshlrev_b32 v26, 16, v145
    v_and_b32 v27, 0xffff0000, v145
    v_lshlrev_b32 v28, 16, v146
    v_and_b32 v29, 0xffff0000, v146
    v_lshlrev_b32 v30, 16, v147
    v_and_b32 v31, 0xffff0000, v147
    v_lshlrev_b32 v32, 16, v148
    v_and_b32 v33, 0xffff0000, v148
    v_lshlrev_b32 v34, 16, v149
    v_and_b32 v35, 0xffff0000, v149
    v_lshlrev_b32 v36, 16, v150
    v_and_b32 v37, 0xffff0000, v150
    v_lshlrev_b32 v38, 16, v151
    v_and_b32 v39, 0xffff0000, v151
    v_mul_f32 v24, 0x3d93cd3a, v24
    v_mul_f32 v25, 0x3d93cd3a, v25
    v_mul_f32 v26, 0x3d93cd3a, v26
    v_mul_f32 v27, 0x3d93cd3a, v27
    v_mul_f32 v28, 0x3d93cd3a, v28
    v_mul_f32 v29, 0x3d93cd3a, v29
    v_mul_f32 v30, 0x3d93cd3a, v30
    v_mul_f32 v31, 0x3d93cd3a, v31
    v_mul_f32 v32, 0x3d93cd3a, v32
    v_mul_f32 v33, 0x3d93cd3a, v33
    v_mul_f32 v34, 0x3d93cd3a, v34
    v_mul_f32 v35, 0x3d93cd3a, v35
    v_mul_f32 v36, 0x3d93cd3a, v36
    v_mul_f32 v37, 0x3d93cd3a, v37
    v_mul_f32 v38, 0x3d93cd3a, v38
    v_mul_f32 v39, 0x3d93cd3a, v39
    v_cvt_pk_bf16_f32 v144, v24, v25
    v_cvt_pk_bf16_f32 v145, v26, v27
    v_cvt_pk_bf16_f32 v146, v28, v29
    v_cvt_pk_bf16_f32 v147, v30, v31
    v_cvt_pk_bf16_f32 v148, v32, v33
    v_cvt_pk_bf16_f32 v149, v34, v35
    v_cvt_pk_bf16_f32 v150, v36, v37
    v_cvt_pk_bf16_f32 v151, v38, v39
    v_lshlrev_b32 v24, 16, v144
    v_and_b32 v25, 0xffff0000, v144
    v_lshlrev_b32 v26, 16, v145
    v_and_b32 v27, 0xffff0000, v145
    v_lshlrev_b32 v28, 16, v146
    v_and_b32 v29, 0xffff0000, v146
    v_lshlrev_b32 v30, 16, v147
    v_and_b32 v31, 0xffff0000, v147
    v_lshlrev_b32 v32, 16, v148
    v_and_b32 v33, 0xffff0000, v148
    v_lshlrev_b32 v34, 16, v149
    v_and_b32 v35, 0xffff0000, v149
    v_lshlrev_b32 v36, 16, v150
    v_and_b32 v37, 0xffff0000, v150
    v_lshlrev_b32 v38, 16, v151
    v_and_b32 v39, 0xffff0000, v151
    v_max_f32 v20, v24, v25
    v_max3_f32 v20, v20, v26, v27
    v_max3_f32 v20, v20, v28, v29
    v_max3_f32 v20, v20, v30, v31
    v_max3_f32 v20, v20, v32, v33
    v_max3_f32 v20, v20, v34, v35
    v_max3_f32 v20, v20, v36, v37
    v_max3_f32 v20, v20, v38, v39
    s_nop 1
    v_max_f32_dpp v20, v20, v20 quad_perm:[1,0,3,2] row_mask:0xf bank_mask:0xf
    s_nop 1
    v_max_f32_dpp v20, v20, v20 quad_perm:[2,3,0,1] row_mask:0xf bank_mask:0xf
    s_nop 1
    v_max_f32_dpp v20, v20, v20 row_half_mirror row_mask:0xf bank_mask:0xf
    v_sub_f32 v24, v24, v20
    v_sub_f32 v25, v25, v20
    v_sub_f32 v26, v26, v20
    v_sub_f32 v27, v27, v20
    v_sub_f32 v28, v28, v20
    v_sub_f32 v29, v29, v20
    v_sub_f32 v30, v30, v20
    v_sub_f32 v31, v31, v20
    v_sub_f32 v32, v32, v20
    v_sub_f32 v33, v33, v20
    v_sub_f32 v34, v34, v20
    v_sub_f32 v35, v35, v20
    v_sub_f32 v36, v36, v20
    v_sub_f32 v37, v37, v20
    v_sub_f32 v38, v38, v20
    v_sub_f32 v39, v39, v20
    v_mul_f32 v24, 0x3fb8aa3b, v24
    v_mul_f32 v25, 0x3fb8aa3b, v25
    v_mul_f32 v26, 0x3fb8aa3b, v26
    v_mul_f32 v27, 0x3fb8aa3b, v27
    v_mul_f32 v28, 0x3fb8aa3b, v28
    v_mul_f32 v29, 0x3fb8aa3b, v29
    v_mul_f32 v30, 0x3fb8aa3b, v30
    v_mul_f32 v31, 0x3fb8aa3b, v31
    v_mul_f32 v32, 0x3fb8aa3b, v32
    v_mul_f32 v33, 0x3fb8aa3b, v33
    v_mul_f32 v34, 0x3fb8aa3b, v34
    v_mul_f32 v35, 0x3fb8aa3b, v35
    v_mul_f32 v36, 0x3fb8aa3b, v36
    v_mul_f32 v37, 0x3fb8aa3b, v37
    v_mul_f32 v38, 0x3fb8aa3b, v38
    v_mul_f32 v39, 0x3fb8aa3b, v39
    v_exp_f32 v24, v24
    v_exp_f32 v25, v25
    v_exp_f32 v26, v26
    v_exp_f32 v27, v27
    v_exp_f32 v28, v28
    v_exp_f32 v29, v29
    v_exp_f32 v30, v30
    v_exp_f32 v31, v31
    v_exp_f32 v32, v32
    v_exp_f32 v33, v33
    v_exp_f32 v34, v34
    v_exp_f32 v35, v35
    v_exp_f32 v36, v36
    v_exp_f32 v37, v37
    v_exp_f32 v38, v38
    v_exp_f32 v39, v39
    s_nop 0
    v_add_f32 v21, v24, v25
    v_add_f32 v21, v21, v26
    v_add_f32 v21, v21, v27
    v_add_f32 v21, v21, v28
    v_add_f32 v21, v21, v29
    v_add_f32 v21, v21, v30
    v_add_f32 v21, v21, v31
    v_add_f32 v21, v21, v32
    v_add_f32 v21, v21, v33
    v_add_f32 v21, v21, v34
    v_add_f32 v21, v21, v35
    v_add_f32 v21, v21, v36
    v_add_f32 v21, v21, v37
    v_add_f32 v21, v21, v38
    v_add_f32 v21, v21, v39
    s_nop 1
    v_add_f32_dpp v21, v21, v21 quad_perm:[1,0,3,2] row_mask:0xf bank_mask:0xf
    s_nop 1
    v_add_f32_dpp v21, v21, v21 quad_perm:[2,3,0,1] row_mask:0xf bank_mask:0xf
    s_nop 1
    v_add_f32_dpp v21, v21, v21 row_half_mirror row_mask:0xf bank_mask:0xf
    v_mov_b32 v161, s60
    v_mov_b32 v163, s60
    s_lshl_b32 s6, s4, 11
    s_lshl_b32 s7, s5, 6
    s_add_u32 s6, s6, s7
    s_add_u32 s6, s6, 262144
    s_mov_b64 exec, 7
    buffer_store_dwordx4 v[160:163], v19, s[44:47], s6 offen sc1
    s_mov_b64 exec, -1
    s_nop 1
    s_lshl_b32 s6, s4, 12
    s_lshl_b32 s7, s5, 7
    s_add_u32 s6, s6, s7
    s_add_u32 s6, s6, 294912
    v_lshlrev_b32 v11, 5, v2
    ds_bpermute_b32 v24, v11, v20
    ds_bpermute_b32 v26, v11, v21
    v_mov_b32 v25, s60
    v_mov_b32 v27, s60
    s_waitcnt lgkmcnt(0)
    s_mov_b64 exec, 0xff
    buffer_store_dwordx4 v[24:27], v19, s[44:47], s6 offen sc1
    s_mov_b64 exec, -1
    s_nop 1
    s_mov_b32 s62, 4000000
    v_mov_b32 v8, 0
L_wl_44:
    ds_read_b64 v[4:5], v8 offset:8
    s_waitcnt lgkmcnt(0)
    v_min_u32 v4, v4, v5
    s_nop 0
    v_readfirstlane_b32 s63, v4
    s_cmp_ge_u32 s63, 28
    s_cbranch_scc1 L_wlok_45
    s_sleep 8
    s_sub_u32 s62, s62, 1
    s_cmp_lg_u32 s62, 0
    s_cbranch_scc1 L_wl_44
    s_endpgm
L_wlok_45:
    v_and_b32 v11, 31, v0
    v_lshlrev_b32 v11, 6, v11
    s_lshl_b32 s6, s4, 11
    s_add_u32 s6, s6, 262144
    s_mov_b32 s62, 400000
L_gt_46:
    buffer_load_dwordx4 v[164:167], v11, s[44:47], s6 offen offset:0 sc1
    buffer_load_dwordx4 v[168:171], v11, s[44:47], s6 offen offset:16 sc1
    buffer_load_dwordx4 v[172:175], v11, s[44:47], s6 offen offset:32 sc1
L_gtmid_48:
    v_mov_b32 v4, 0
    v_mov_b32 v5, 0
    s_waitcnt vmcnt(0)
    v_bitop3_b32 v4, v4, v165, s60 bitop3:0xf6
    v_bitop3_b32 v4, v4, v167, s60 bitop3:0xf6
    v_bitop3_b32 v4, v4, v169, s60 bitop3:0xf6
    v_bitop3_b32 v4, v4, v171, s60 bitop3:0xf6
    v_bitop3_b32 v4, v4, v173, s60 bitop3:0xf6
    v_bitop3_b32 v4, v4, v175, s60 bitop3:0xf6
    v_cmp_ne_u32 vcc, 0, v4
    s_nop 4
    s_cbranch_vccz L_gtok_47
    s_sleep 32
    s_sub_u32 s62, s62, 1
    s_cmp_lg_u32 s62, 0
    s_cbranch_scc1 L_gt_46
    s_endpgm
L_gtok_47:
    v_cmp_ne_u32 vcc, s59, v172
    s_nop 1
    s_cmp_eq_u64 vcc, 0
    s_cselect_b32 s59, 1, 0
    s_waitcnt lgkmcnt(0)
    v_mov_b32 v4, 48
    v_mov_b32 v5, s59
    ds_write_b32 v4, v5
    v_mov_b32 v20, v164
    s_nop 1
    v_max_f32_dpp v20, v20, v20 quad_perm:[1,0,3,2] row_mask:0xf bank_mask:0xf
    s_nop 1
    v_max_f32_dpp v20, v20, v20 quad_perm:[2,3,0,1] row_mask:0xf bank_mask:0xf
    s_nop 1
    v_max_f32_dpp v20, v20, v20 row_half_mirror row_mask:0xf bank_mask:0xf
    s_nop 1
    v_max_f32_dpp v20, v20, v20 row_mirror row_mask:0xf bank_mask:0xf
    v_mov_b32 v10, v20
    s_nop 1
    v_permlane16_swap_b32 v20, v10
    s_nop 1
    v_max_f32 v20, v20, v10
    v_mov_b32 v10, v20
    s_nop 1
    v_permlane32_swap_b32 v20, v10
    s_nop 1
    v_max_f32 v20, v20, v10
    v_sub_f32 v164, v164, v20
    v_mul_f32 v164, 0x3fb8aa3b, v164
    v_exp_f32 v164, v164
    s_nop 0
    v_mul_f32 v21, v164, v166
    s_nop 1
    v_add_f32_dpp v21, v21, v21 quad_perm:[1,0,3,2] row_mask:0xf bank_mask:0xf
    s_nop 1
    v_add_f32_dpp v21, v21, v21 quad_perm:[2,3,0,1] row_mask:0xf bank_mask:0xf
    s_nop 1
    v_add_f32_dpp v21, v21, v21 row_half_mirror row_mask:0xf bank_mask:0xf
    s_nop 1
    v_add_f32_dpp v21, v21, v21 row_mirror row_mask:0xf bank_mask:0xf
    v_mov_b32 v10, v21
    s_nop 1
    v_permlane16_swap_b32 v21, v10
    s_nop 1
    v_add_f32 v21, v21, v10
    v_mov_b32 v10, v21
    s_nop 1
    v_permlane32_swap_b32 v21, v10
    s_nop 1
    v_add_f32 v21, v21, v10
    v_mul_f32 v21, 0.5, v21
    v_rcp_f32 v21, v21
    v_lshlrev_b32 v24, 16, v128
    v_and_b32 v25, 0xffff0000, v128
    v_lshlrev_b32 v26, 16, v129
    v_and_b32 v27, 0xffff0000, v129
    v_lshlrev_b32 v28, 16, v130
    v_and_b32 v29, 0xffff0000, v130
    v_lshlrev_b32 v30, 16, v131
    v_and_b32 v31, 0xffff0000, v131
    v_lshlrev_b32 v32, 16, v132
    v_and_b32 v33, 0xffff0000, v132
    v_lshlrev_b32 v34, 16, v133
    v_and_b32 v35, 0xffff0000, v133
    v_lshlrev_b32 v36, 16, v134
    v_and_b32 v37, 0xffff0000, v134
    v_lshlrev_b32 v38, 16, v135
    v_and_b32 v39, 0xffff0000, v135
    v_sub_f32 v24, v24, v20
    v_sub_f32 v25, v25, v20
    v_sub_f32 v26, v26, v20
    v_sub_f32 v27, v27, v20
    v_sub_f32 v28, v28, v20
    v_sub_f32 v29, v29, v20
    v_sub_f32 v30, v30, v20
    v_sub_f32 v31, v31, v20
    v_sub_f32 v32, v32, v20
    v_sub_f32 v33, v33, v20
    v_sub_f32 v34, v34, v20
    v_sub_f32 v35, v35, v20
    v_sub_f32 v36, v36, v20
    v_sub_f32 v37, v37, v20
    v_sub_f32 v38, v38, v20
    v_sub_f32 v39, v39, v20
    v_mul_f32 v24, 0x3fb8aa3b, v24
    v_mul_f32 v25, 0x3fb8aa3b, v25
    v_mul_f32 v26, 0x3fb8aa3b, v26
    v_mul_f32 v27, 0x3fb8aa3b, v27
    v_mul_f32 v28, 0x3fb8aa3b, v28
    v_mul_f32 v29, 0x3fb8aa3b, v29
    v_mul_f32 v30, 0x3fb8aa3b, v30
    v_mul_f32 v31, 0x3fb8aa3b, v31
    v_mul_f32 v32, 0x3fb8aa3b, v32
    v_mul_f32 v33, 0x3fb8aa3b, v33
    v_mul_f32 v34, 0x3fb8aa3b, v34
    v_mul_f32 v35, 0x3fb8aa3b, v35
    v_mul_f32 v36, 0x3fb8aa3b, v36
    v_mul_f32 v37, 0x3fb8aa3b, v37
    v_mul_f32 v38, 0x3fb8aa3b, v38
    v_mul_f32 v39, 0x3fb8aa3b, v39
    v_exp_f32 v24, v24
    v_exp_f32 v25, v25
    v_exp_f32 v26, v26
    v_exp_f32 v27, v27
    v_exp_f32 v28, v28
    v_exp_f32 v29, v29
    v_exp_f32 v30, v30
    v_exp_f32 v31, v31
    v_exp_f32 v32, v32
    v_exp_f32 v33, v33
    v_exp_f32 v34, v34
    v_exp_f32 v35, v35
    v_exp_f32 v36, v36
    v_exp_f32 v37, v37
    v_exp_f32 v38, v38
    v_exp_f32 v39, v39
    s_nop 0
    v_mul_f32 v24, v24, v21
    v_mul_f32 v25, v25, v21
    v_mul_f32 v26, v26, v21
    v_mul_f32 v27, v27, v21
    v_mul_f32 v28, v28, v21
    v_mul_f32 v29, v29, v21
    v_mul_f32 v30, v30, v21
    v_mul_f32 v31, v31, v21
    v_mul_f32 v32, v32, v21
    v_mul_f32 v33, v33, v21
    v_mul_f32 v34, v34, v21
    v_mul_f32 v35, v35, v21
    v_mul_f32 v36, v36, v21
    v_mul_f32 v37, v37, v21
    v_mul_f32 v38, v38, v21
    v_mul_f32 v39, v39, v21
    v_cvt_pk_bf16_f32 v128, v24, v25
    v_cvt_pk_bf16_f32 v129, v26, v27
    v_cvt_pk_bf16_f32 v130, v28, v29
    v_cvt_pk_bf16_f32 v131, v30, v31
    v_cvt_pk_bf16_f32 v132, v32, v33
    v_cvt_pk_bf16_f32 v133, v34, v35
    v_cvt_pk_bf16_f32 v134, v36, v37
    v_cvt_pk_bf16_f32 v135, v38, v39
    ds_write_b128 v22, v[128:131] offset:5632
    ds_write_b128 v22, v[132:135] offset:5648
    v_mov_b32 v20, v168
    s_nop 1
    v_max_f32_dpp v20, v20, v20 quad_perm:[1,0,3,2] row_mask:0xf bank_mask:0xf
    s_nop 1
    v_max_f32_dpp v20, v20, v20 quad_perm:[2,3,0,1] row_mask:0xf bank_mask:0xf
    s_nop 1
    v_max_f32_dpp v20, v20, v20 row_half_mirror row_mask:0xf bank_mask:0xf
    s_nop 1
    v_max_f32_dpp v20, v20, v20 row_mirror row_mask:0xf bank_mask:0xf
    v_mov_b32 v10, v20
    s_nop 1
    v_permlane16_swap_b32 v20, v10
    s_nop 1
    v_max_f32 v20, v20, v10
    v_mov_b32 v10, v20
    s_nop 1
    v_permlane32_swap_b32 v20, v10
    s_nop 1
    v_max_f32 v20, v20, v10
    v_sub_f32 v168, v168, v20
    v_mul_f32 v168, 0x3fb8aa3b, v168
    v_exp_f32 v168, v168
    s_nop 0
    v_mul_f32 v21, v168, v170
    s_nop 1
    v_add_f32_dpp v21, v21, v21 quad_perm:[1,0,3,2] row_mask:0xf bank_mask:0xf
    s_nop 1
    v_add_f32_dpp v21, v21, v21 quad_perm:[2,3,0,1] row_mask:0xf bank_mask:0xf
    s_nop 1
    v_add_f32_dpp v21, v21, v21 row_half_mirror row_mask:0xf bank_mask:0xf
    s_nop 1
    v_add_f32_dpp v21, v21, v21 row_mirror row_mask:0xf bank_mask:0xf
    v_mov_b32 v10, v21
    s_nop 1
    v_permlane16_swap_b32 v21, v10
    s_nop 1
    v_add_f32 v21, v21, v10
    v_mov_b32 v10, v21
    s_nop 1
    v_permlane32_swap_b32 v21, v10
    s_nop 1
    v_add_f32 v21, v21, v10
    v_mul_f32 v21, 0.5, v21
    v_rcp_f32 v21, v21
    v_lshlrev_b32 v24, 16, v136
    v_and_b32 v25, 0xffff0000, v136
    v_lshlrev_b32 v26, 16, v137
    v_and_b32 v27, 0xffff0000, v137
    v_lshlrev_b32 v28, 16, v138
    v_and_b32 v29, 0xffff0000, v138
    v_lshlrev_b32 v30, 16, v139
    v_and_b32 v31, 0xffff0000, v139
    v_lshlrev_b32 v32, 16, v140
    v_and_b32 v33, 0xffff0000, v140
    v_lshlrev_b32 v34, 16, v141
    v_and_b32 v35, 0xffff0000, v141
    v_lshlrev_b32 v36, 16, v142
    v_and_b32 v37, 0xffff0000, v142
    v_lshlrev_b32 v38, 16, v143
    v_and_b32 v39, 0xffff0000, v143
    v_sub_f32 v24, v24, v20
    v_sub_f32 v25, v25, v20
    v_sub_f32 v26, v26, v20
    v_sub_f32 v27, v27, v20
    v_sub_f32 v28, v28, v20
    v_sub_f32 v29, v29, v20
    v_sub_f32 v30, v30, v20
    v_sub_f32 v31, v31, v20
    v_sub_f32 v32, v32, v20
    v_sub_f32 v33, v33, v20
    v_sub_f32 v34, v34, v20
    v_sub_f32 v35, v35, v20
    v_sub_f32 v36, v36, v20
    v_sub_f32 v37, v37, v20
    v_sub_f32 v38, v38, v20
    v_sub_f32 v39, v39, v20
    v_mul_f32 v24, 0x3fb8aa3b, v24
    v_mul_f32 v25, 0x3fb8aa3b, v25
    v_mul_f32 v26, 0x3fb8aa3b, v26
    v_mul_f32 v27, 0x3fb8aa3b, v27
    v_mul_f32 v28, 0x3fb8aa3b, v28
    v_mul_f32 v29, 0x3fb8aa3b, v29
    v_mul_f32 v30, 0x3fb8aa3b, v30
    v_mul_f32 v31, 0x3fb8aa3b, v31
    v_mul_f32 v32, 0x3fb8aa3b, v32
    v_mul_f32 v33, 0x3fb8aa3b, v33
    v_mul_f32 v34, 0x3fb8aa3b, v34
    v_mul_f32 v35, 0x3fb8aa3b, v35
    v_mul_f32 v36, 0x3fb8aa3b, v36
    v_mul_f32 v37, 0x3fb8aa3b, v37
    v_mul_f32 v38, 0x3fb8aa3b, v38
    v_mul_f32 v39, 0x3fb8aa3b, v39
    v_exp_f32 v24, v24
    v_exp_f32 v25, v25
    v_exp_f32 v26, v26
    v_exp_f32 v27, v27
    v_exp_f32 v28, v28
    v_exp_f32 v29, v29
    v_exp_f32 v30, v30
    v_exp_f32 v31, v31
    v_exp_f32 v32, v32
    v_exp_f32 v33, v33
    v_exp_f32 v34, v34
    v_exp_f32 v35, v35
    v_exp_f32 v36, v36
    v_exp_f32 v37, v37
    v_exp_f32 v38, v38
    v_exp_f32 v39, v39
    s_nop 0
    v_mul_f32 v24, v24, v21
    v_mul_f32 v25, v25, v21
    v_mul_f32 v26, v26, v21
    v_mul_f32 v27, v27, v21
    v_mul_f32 v28, v28, v21
    v_mul_f32 v29, v29, v21
    v_mul_f32 v30, v30, v21
    v_mul_f32 v31, v31, v21
    v_mul_f32 v32, v32, v21
    v_mul_f32 v33, v33, v21
    v_mul_f32 v34, v34, v21
    v_mul_f32 v35, v35, v21
    v_mul_f32 v36, v36, v21
    v_mul_f32 v37, v37, v21
    v_mul_f32 v38, v38, v21
    v_mul_f32 v39, v39, v21
    v_cvt_pk_bf16_f32 v136, v24, v25
    v_cvt_pk_bf16_f32 v137, v26, v27
    v_cvt_pk_bf16_f32 v138, v28, v29
    v_cvt_pk_bf16_f32 v139, v30, v31
    v_cvt_pk_bf16_f32 v140, v32, v33
    v_cvt_pk_bf16_f32 v141, v34, v35
    v_cvt_pk_bf16_f32 v142, v36, v37
    v_cvt_pk_bf16_f32 v143, v38, v39
    ds_write_b128 v22, v[136:139] offset:7680
    ds_write_b128 v22, v[140:143] offset:7696
    s_waitcnt lgkmcnt(0)
    v_mov_b32 v4, 20
    v_mov_b32 v5, 2
    ds_write_b32 v4, v5
    s_cmp_lg_u32 s5, 31
    s_cbranch_scc1 L_ha_nomerge
    s_lshl_b32 s6, s4, 12
    s_add_u32 s6, s6, 294912
    v_lshlrev_b32 v11, 4, v1
    v_lshl_add_u32 v11, v2, 7, v11
    s_mov_b32 s62, 400000
L_gt_49:
    buffer_load_dwordx4 v[164:167], v11, s[44:47], s6 offen offset:0 sc1
    buffer_load_dwordx4 v[168:171], v11, s[44:47], s6 offen offset:1024 sc1
    buffer_load_dwordx4 v[172:175], v11, s[44:47], s6 offen offset:2048 sc1
    buffer_load_dwordx4 v[176:179], v11, s[44:47], s6 offen offset:3072 sc1
L_gtmid_51:
    v_mov_b32 v4, 0
    v_mov_b32 v5, 0
    s_waitcnt vmcnt(0)
    v_bitop3_b32 v4, v4, v165, s60 bitop3:0xf6
    v_bitop3_b32 v4, v4, v167, s60 bitop3:0xf6
    v_bitop3_b32 v4, v4, v169, s60 bitop3:0xf6
    v_bitop3_b32 v4, v4, v171, s60 bitop3:0xf6
    v_bitop3_b32 v4, v4, v173, s60 bitop3:0xf6
    v_bitop3_b32 v4, v4, v175, s60 bitop3:0xf6
    v_bitop3_b32 v4, v4, v177, s60 bitop3:0xf6
    v_bitop3_b32 v4, v4, v179, s60 bitop3:0xf6
    v_cmp_ne_u32 vcc, 0, v4
    s_nop 4
    s_cbranch_vccz L_gtok_50
    s_sleep 32
    s_sub_u32 s62, s62, 1
    s_cmp_lg_u32 s62, 0
    s_cbranch_scc1 L_gt_49
    s_endpgm
L_gtok_50:
    v_mov_b32 v20, v164
    v_max_f32 v20, v20, v168
    v_max_f32 v20, v20, v172
    v_max_f32 v20, v20, v176
    s_nop 1
    v_max_f32_dpp v20, v20, v20 quad_perm:[1,0,3,2] row_mask:0xf bank_mask:0xf
    s_nop 1
    v_max_f32_dpp v20, v20, v20 quad_perm:[2,3,0,1] row_mask:0xf bank_mask:0xf
    s_nop 1
    v_max_f32_dpp v20, v20, v20 row_half_mirror row_mask:0xf bank_mask:0xf
    v_sub_f32 v164, v164, v20
    v_mul_f32 v164, 0x3fb8aa3b, v164
    v_exp_f32 v164, v164
    v_sub_f32 v168, v168, v20
    v_mul_f32 v168, 0x3fb8aa3b, v168
    v_exp_f32 v168, v168
    v_sub_f32 v172, v172, v20
    v_mul_f32 v172, 0x3fb8aa3b, v172
    v_exp_f32 v172, v172
    v_sub_f32 v176, v176, v20
    v_mul_f32 v176, 0x3fb8aa3b, v176
    v_exp_f32 v176, v176
    s_nop 0
    v_mul_f32 v21, v164, v166
    v_fmac_f32 v21, v168, v170
    v_fmac_f32 v21, v172, v174
    v_fmac_f32 v21, v176, v178
    s_nop 1
    v_add_f32_dpp v21, v21, v21 quad_perm:[1,0,3,2] row_mask:0xf bank_mask:0xf
    s_nop 1
    v_add_f32_dpp v21, v21, v21 quad_perm:[2,3,0,1] row_mask:0xf bank_mask:0xf
    s_nop 1
    v_add_f32_dpp v21, v21, v21 row_half_mirror row_mask:0xf bank_mask:0xf
    s_lshl_b32 s6, s4, 7
    s_add_u32 s6, s6, 458752
    v_lshlrev_b32 v11, 5, v2
    ds_bpermute_b32 v24, v11, v20
    ds_bpermute_b32 v26, v11, v21
    v_mov_b32 v25, s60
    v_mov_b32 v27, s60
    s_waitcnt lgkmcnt(0)
    s_mov_b64 exec, 0xff
    buffer_store_dwordx4 v[24:27], v19, s[44:47], s6 offen sc1
    s_mov_b64 exec, -1
    s_nop 1
L_ha_nomerge:
    v_mov_b32 v24, -1
    v_mov_b32 v25, -1
    v_mov_b32 v26, -1
    v_mov_b32 v27, -1
    s_mul_i32 s6, s4, 270336
    s_mul_i32 s7, s5, 768
    s_add_u32 s6, s6, s7
    s_add_u32 s6, s6, 1163264
    s_mov_b32 exec_hi, 0xffff
    s_cmp_eq_u32 s59, 0
    s_cbranch_scc1 L_ha_mark_far
    buffer_store_dwordx4 v[24:27], v19, s[44:47], s6 offen
    s_branch L_ha_marked
L_ha_mark_far:
    buffer_store_dwordx4 v[24:27], v19, s[44:47], s6 offen sc1
L_ha_marked:
    s_mov_b64 exec, -1
    s_waitcnt vmcnt(0)
    s_mov_b32 s62, 4000000
    v_mov_b32 v8, 0
L_wl_52:
    ds_read_b64 v[4:5], v8 offset:8
    s_waitcnt lgkmcnt(0)
    v_min_u32 v4, v4, v5
    s_nop 0
    v_readfirstlane_b32 s63, v4
    s_cmp_ge_u32 s63, 32
    s_cbranch_scc1 L_wlok_53
    s_sleep 8
    s_sub_u32 s62, s62, 1
    s_cmp_lg_u32 s62, 0
    s_cbranch_scc1 L_wl_52
    s_endpgm
L_wlok_53:
    v_lshlrev_b32 v22, 5, v0
    ds_read_b128 v[152:155], v22 offset:11776
    ds_read_b128 v[156:159], v22 offset:11792
    s_waitcnt lgkmcnt(0)
    v_lshlrev_b32 v24, 16, v152
    v_and_b32 v25, 0xffff0000, v152
    v_lshlrev_b32 v26, 16, v153
    v_and_b32 v27, 0xffff0000, v153
    v_lshlrev_b32 v28, 16, v154
    v_and_b32 v29, 0xffff0000, v154
    v_lshlrev_b32 v30, 16, v155
    v_and_b32 v31, 0xffff0000, v155
    v_lshlrev_b32 v32, 16, v156
    v_and_b32 v33, 0xffff0000, v156
    v_lshlrev_b32 v34, 16, v157
    v_and_b32 v35, 0xffff0000, v157
    v_lshlrev_b32 v36, 16, v158
    v_and_b32 v37, 0xffff0000, v158
    v_lshlrev_b32 v38, 16, v159
    v_and_b32 v39, 0xffff0000, v159
    v_mul_f32 v24, 0x3d93cd3a, v24
    v_mul_f32 v25, 0x3d93cd3a, v25
    v_mul_f32 v26, 0x3d93cd3a, v26
    v_mul_f32 v27, 0x3d93cd3a, v27
    v_mul_f32 v28, 0x3d93cd3a, v28
    v_mul_f32 v29, 0x3d93cd3a, v29
    v_mul_f32 v30, 0x3d93cd3a, v30
    v_mul_f32 v31, 0x3d93cd3a, v31
    v_mul_f32 v32, 0x3d93cd3a, v32
    v_mul_f32 v33, 0x3d93cd3a, v33
    v_mul_f32 v34, 0x3d93cd3a, v34
    v_mul_f32 v35, 0x3d93cd3a, v35
    v_mul_f32 v36, 0x3d93cd3a, v36
    v_mul_f32 v37, 0x3d93cd3a, v37
    v_mul_f32 v38, 0x3d93cd3a, v38
    v_mul_f32 v39, 0x3d93cd3a, v39
    v_cvt_pk_bf16_f32 v152, v24, v25
    v_cvt_pk_bf16_f32 v153, v26, v27
    v_cvt_pk_bf16_f32 v154, v28, v29
    v_cvt_pk_bf16_f32 v155, v30, v31
    v_cvt_pk_bf16_f32 v156, v32, v33
    v_cvt_pk_bf16_f32 v157, v34, v35
    v_cvt_pk_bf16_f32 v158, v36, v37
    v_cvt_pk_bf16_f32 v159, v38, v39
    v_lshlrev_b32 v24, 16, v152
    v_and_b32 v25, 0xffff0000, v152
    v_lshlrev_b32 v26, 16, v153
    v_and_b32 v27, 0xffff0000, v153
    v_lshlrev_b32 v28, 16, v154
    v_and_b32 v29, 0xffff0000, v154
    v_lshlrev_b32 v30, 16, v155
    v_and_b32 v31, 0xffff0000, v155
    v_lshlrev_b32 v32, 16, v156
    v_and_b32 v33, 0xffff0000, v156
    v_lshlrev_b32 v34, 16, v157
    v_and_b32 v35, 0xffff0000, v157
    v_lshlrev_b32 v36, 16, v158
    v_and_b32 v37, 0xffff0000, v158
    v_lshlrev_b32 v38, 16, v159
    v_and_b32 v39, 0xffff0000, v159
    v_max_f32 v20, v24, v25
    v_max3_f32 v20, v20, v26, v27
    v_max3_f32 v20, v20, v28, v29
    v_max3_f32 v20, v20, v30, v31
    v_max3_f32 v20, v20, v32, v33
    v_max3_f32 v20, v20, v34, v35
    v_max3_f32 v20, v20, v36, v37
    v_max3_f32 v20, v20, v38, v39
    s_nop 1
    v_max_f32_dpp v20, v20, v20 quad_perm:[1,0,3,2] row_mask:0xf bank_mask:0xf
    s_nop 1
    v_max_f32_dpp v20, v20, v20 quad_perm:[2,3,0,1] row_mask:0xf bank_mask:0xf
    s_nop 1
    v_max_f32_dpp v20, v20, v20 row_half_mirror row_mask:0xf bank_mask:0xf
    s_nop 1
    v_max_f32_dpp v20, v20, v20 row_mirror row_mask:0xf bank_mask:0xf
    v_mov_b32 v10, v20
    s_nop 1
    v_permlane16_swap_b32 v20, v10
    s_nop 1
    v_max_f32 v20, v20, v10
    v_mov_b32 v10, v20
    s_nop 1
    v_permlane32_swap_b32 v20, v10
    s_nop 1
    v_max_f32 v20, v20, v10
    v_sub_f32 v24, v24, v20
    v_sub_f32 v25, v25, v20
    v_sub_f32 v26, v26, v20
    v_sub_f32 v27, v27, v20
    v_sub_f32 v28, v28, v20
    v_sub_f32 v29, v29, v20
    v_sub_f32 v30, v30, v20
    v_sub_f32 v31, v31, v20
    v_sub_f32 v32, v32, v20
    v_sub_f32 v33, v33, v20
    v_sub_f32 v34, v34, v20
    v_sub_f32 v35, v35, v20
    v_sub_f32 v36, v36, v20
    v_sub_f32 v37, v37, v20
    v_sub_f32 v38, v38, v20
    v_sub_f32 v39, v39, v20
    v_mul_f32 v24, 0x3fb8aa3b, v24
    v_mul_f32 v25, 0x3fb8aa3b, v25
    v_mul_f32 v26, 0x3fb8aa3b, v26
    v_mul_f32 v27, 0x3fb8aa3b, v27
    v_mul_f32 v28, 0x3fb8aa3b, v28
    v_mul_f32 v29, 0x3fb8aa3b, v29
    v_mul_f32 v30, 0x3fb8aa3b, v30
    v_mul_f32 v31, 0x3fb8aa3b, v31
    v_mul_f32 v32, 0x3fb8aa3b, v32
    v_mul_f32 v33, 0x3fb8aa3b, v33
    v_mul_f32 v34, 0x3fb8aa3b, v34
    v_mul_f32 v35, 0x3fb8aa3b, v35
    v_mul_f32 v36, 0x3fb8aa3b, v36
    v_mul_f32 v37, 0x3fb8aa3b, v37
    v_mul_f32 v38, 0x3fb8aa3b, v38
    v_mul_f32 v39, 0x3fb8aa3b, v39
    v_exp_f32 v24, v24
    v_exp_f32 v25, v25
    v_exp_f32 v26, v26
    v_exp_f32 v27, v27
    v_exp_f32 v28, v28
    v_exp_f32 v29, v29
    v_exp_f32 v30, v30
    v_exp_f32 v31, v31
    v_exp_f32 v32, v32
    v_exp_f32 v33, v33
    v_exp_f32 v34, v34
    v_exp_f32 v35, v35
    v_exp_f32 v36, v36
    v_exp_f32 v37, v37
    v_exp_f32 v38, v38
    v_exp_f32 v39, v39
    s_nop 0
    v_add_f32 v21, v24, v25
    v_add_f32 v21, v21, v26
    v_add_f32 v21, v21, v27
    v_add_f32 v21, v21, v28
    v_add_f32 v21, v21, v29
    v_add_f32 v21, v21, v30
    v_add_f32 v21, v21, v31
    v_add_f32 v21, v21, v32
    v_add_f32 v21, v21, v33
    v_add_f32 v21, v21, v34
    v_add_f32 v21, v21, v35
    v_add_f32 v21, v21, v36
    v_add_f32 v21, v21, v37
    v_add_f32 v21, v21, v38
    v_add_f32 v21, v21, v39
    s_nop 1
    v_add_f32_dpp v21, v21, v21 quad_perm:[1,0,3,2] row_mask:0xf bank_mask:0xf
    s_nop 1
    v_add_f32_dpp v21, v21, v21 quad_perm:[2,3,0,1] row_mask:0xf bank_mask:0xf
    s_nop 1
    v_add_f32_dpp v21, v21, v21 row_half_mirror row_mask:0xf bank_mask:0xf
    s_nop 1
    v_add_f32_dpp v21, v21, v21 row_mirror row_mask:0xf bank_mask:0xf
    v_mov_b32 v10, v21
    s_nop 1
    v_permlane16_swap_b32 v21, v10
    s_nop 1
    v_add_f32 v21, v21, v10
    v_mov_b32 v10, v21
    s_nop 1
    v_permlane32_swap_b32 v21, v10
    s_nop 1
    v_add_f32 v21, v21, v10
    v_cmp_eq_u32 vcc, 0, v0
    s_nop 1
    v_cndmask_b32 v160, v160, v20, vcc
    v_cndmask_b32 v162, v162, v21, vcc
    v_mov_b32 v161, s60
    v_mov_b32 v163, s60
    s_lshl_b32 s6, s4, 9
    s_lshl_b32 s7, s5, 4
    s_add_u32 s6, s6, s7
    s_add_u32 s6, s6, 278528
    s_mov_b64 exec, 1
    buffer_store_dwordx4 v[160:163], v19, s[44:47], s6 offen sc1
    s_mov_b64 exec, -1
    s_nop 1
    s_mov_b32 s62, 4000000
    v_mov_b32 v8, 0
L_wl_54:
    ds_read_b64 v[4:5], v8 offset:8
    s_waitcnt lgkmcnt(0)
    v_min_u32 v4, v4, v5
    s_nop 0
    v_readfirstlane_b32 s63, v4
    s_cmp_ge_u32 s63, 38
    s_cbranch_scc1 L_wlok_55
    s_sleep 8
    s_sub_u32 s62, s62, 1
    s_cmp_lg_u32 s62, 0
    s_cbranch_scc1 L_wl_54
    s_endpgm
L_wlok_55:
    v_and_b32 v11, 31, v0
    v_lshlrev_b32 v11, 4, v11
    s_lshl_b32 s6, s4, 9
    s_add_u32 s6, s6, 278528
    s_mov_b32 s62, 400000
L_gt_56:
    buffer_load_dwordx4 v[164:167], v11, s[44:47], s6 offen offset:0 sc1
L_gtmid_58:
    v_mov_b32 v4, 0
    v_mov_b32 v5, 0
    s_waitcnt vmcnt(0)
    v_bitop3_b32 v4, v4, v165, s60 bitop3:0xf6
    v_bitop3_b32 v4, v4, v167, s60 bitop3:0xf6
    v_cmp_ne_u32 vcc, 0, v4
    s_nop 4
    s_cbranch_vccz L_gtok_57
    s_sleep 32
    s_sub_u32 s62, s62, 1
    s_cmp_lg_u32 s62, 0
    s_cbranch_scc1 L_gt_56
    s_endpgm
L_gtok_57:
    v_mov_b32 v20, v164
    s_nop 1
    v_max_f32_dpp v20, v20, v20 quad_perm:[1,0,3,2] row_mask:0xf bank_mask:0xf
    s_nop 1
    v_max_f32_dpp v20, v20, v20 quad_perm:[2,3,0,1] row_mask:0xf bank_mask:0xf
    s_nop 1
    v_max_f32_dpp v20, v20, v20 row_half_mirror row_mask:0xf bank_mask:0xf
    s_nop 1
    v_max_f32_dpp v20, v20, v20 row_mirror row_mask:0xf bank_mask:0xf
    v_mov_b32 v10, v20
    s_nop 1
    v_permlane16_swap_b32 v20, v10
    s_nop 1
    v_max_f32 v20, v20, v10
    v_mov_b32 v10, v20
    s_nop 1
    v_permlane32_swap_b32 v20, v10
    s_nop 1
    v_max_f32 v20, v20, v10
    v_sub_f32 v164, v164, v20
    v_mul_f32 v164, 0x3fb8aa3b, v164
    v_exp_f32 v164, v164
    s_nop 0
    v_mul_f32 v21, v164, v166
    s_nop 1
    v_add_f32_dpp v21, v21, v21 quad_perm:[1,0,3,2] row_mask:0xf bank_mask:0xf
    s_nop 1
    v_add_f32_dpp v21, v21, v21 quad_perm:[2,3,0,1] row_mask:0xf bank_mask:0xf
    s_nop 1
    v_add_f32_dpp v21, v21, v21 row_half_mirror row_mask:0xf bank_mask:0xf
    s_nop 1
    v_add_f32_dpp v21, v21, v21 row_mirror row_mask:0xf bank_mask:0xf
    v_mov_b32 v10, v21
    s_nop 1
    v_permlane16_swap_b32 v21, v10
    s_nop 1
    v_add_f32 v21, v21, v10
    v_mov_b32 v10, v21
    s_nop 1
    v_permlane32_swap_b32 v21, v10
    s_nop 1
    v_add_f32 v21, v21, v10
    v_mul_f32 v21, 0.5, v21
    v_rcp_f32 v21, v21
    v_lshlrev_b32 v24, 16, v152
    v_and_b32 v25, 0xffff0000, v152
    v_lshlrev_b32 v26, 16, v153
    v_and_b32 v27, 0xffff0000, v153
    v_lshlrev_b32 v28, 16, v154
    v_and_b32 v29, 0xffff0000, v154
    v_lshlrev_b32 v30, 16, v155
    v_and_b32 v31, 0xffff0000, v155
    v_lshlrev_b32 v32, 16, v156
    v_and_b32 v33, 0xffff0000, v156
    v_lshlrev_b32 v34, 16, v157
    v_and_b32 v35, 0xffff0000, v157
    v_lshlrev_b32 v36, 16, v158
    v_and_b32 v37, 0xffff0000, v158
    v_lshlrev_b32 v38, 16, v159
    v_and_b32 v39, 0xffff0000, v159
    v_sub_f32 v24, v24, v20
    v_sub_f32 v25, v25, v20
    v_sub_f32 v26, v26, v20
    v_sub_f32 v27, v27, v20
    v_sub_f32 v28, v28, v20
    v_sub_f32 v29, v29, v20
    v_sub_f32 v30, v30, v20
    v_sub_f32 v31, v31, v20
    v_sub_f32 v32, v32, v20
    v_sub_f32 v33, v33, v20
    v_sub_f32 v34, v34, v20
    v_sub_f32 v35, v35, v20
    v_sub_f32 v36, v36, v20
    v_sub_f32 v37, v37, v20
    v_sub_f32 v38, v38, v20
    v_sub_f32 v39, v39, v20
    v_mul_f32 v24, 0x3fb8aa3b, v24
    v_mul_f32 v25, 0x3fb8aa3b, v25
    v_mul_f32 v26, 0x3fb8aa3b, v26
    v_mul_f32 v27, 0x3fb8aa3b, v27
    v_mul_f32 v28, 0x3fb8aa3b, v28
    v_mul_f32 v29, 0x3fb8aa3b, v29
    v_mul_f32 v30, 0x3fb8aa3b, v30
    v_mul_f32 v31, 0x3fb8aa3b, v31
    v_mul_f32 v32, 0x3fb8aa3b, v32
    v_mul_f32 v33, 0x3fb8aa3b, v33
    v_mul_f32 v34, 0x3fb8aa3b, v34
    v_mul_f32 v35, 0x3fb8aa3b, v35
    v_mul_f32 v36, 0x3fb8aa3b, v36
    v_mul_f32 v37, 0x3fb8aa3b, v37
    v_mul_f32 v38, 0x3fb8aa3b, v38
    v_mul_f32 v39, 0x3fb8aa3b, v39
    v_exp_f32 v24, v24
    v_exp_f32 v25, v25
    v_exp_f32 v26, v26
    v_exp_f32 v27, v27
    v_exp_f32 v28, v28
    v_exp_f32 v29, v29
    v_exp_f32 v30, v30
    v_exp_f32 v31, v31
    v_exp_f32 v32, v32
    v_exp_f32 v33, v33
    v_exp_f32 v34, v34
    v_exp_f32 v35, v35
    v_exp_f32 v36, v36
    v_exp_f32 v37, v37
    v_exp_f32 v38, v38
    v_exp_f32 v39, v39
    s_nop 0
    v_mul_f32 v24, v24, v21
    v_mul_f32 v25, v25, v21
    v_mul_f32 v26, v26, v21
    v_mul_f32 v27, v27, v21
    v_mul_f32 v28, v28, v21
    v_mul_f32 v29, v29, v21
    v_mul_f32 v30, v30, v21
    v_mul_f32 v31, v31, v21
    v_mul_f32 v32, v32, v21
    v_mul_f32 v33, v33, v21
    v_mul_f32 v34, v34, v21
    v_mul_f32 v35, v35, v21
    v_mul_f32 v36, v36, v21
    v_mul_f32 v37, v37, v21
    v_mul_f32 v38, v38, v21
    v_mul_f32 v39, v39, v21
    v_cvt_pk_bf16_f32 v152, v24, v25
    v_cvt_pk_bf16_f32 v153, v26, v27
    v_cvt_pk_bf16_f32 v154, v28, v29
    v_cvt_pk_bf16_f32 v155, v30, v31
    v_cvt_pk_bf16_f32 v156, v32, v33
    v_cvt_pk_bf16_f32 v157, v34, v35
    v_cvt_pk_bf16_f32 v158, v36, v37
    v_cvt_pk_bf16_f32 v159, v38, v39
    ds_write_b128 v22, v[152:155] offset:11776
    ds_write_b128 v22, v[156:159] offset:11792
    s_mov_b32 s6, 458752
    v_lshlrev_b32 v11, 4, v1
    v_lshl_add_u32 v11, v2, 7, v11
    s_mov_b32 s62, 400000
L_gt_59:
    buffer_load_dwordx4 v[172:175], v11, s[44:47], s6 offen offset:0 sc1
L_gtmid_61:
    v_mov_b32 v4, 0
    v_mov_b32 v5, 0
    s_waitcnt vmcnt(0)
    v_bitop3_b32 v4, v4, v173, s60 bitop3:0xf6
    v_bitop3_b32 v4, v4, v175, s60 bitop3:0xf6
    v_cmp_ne_u32 vcc, 0, v4
    s_nop 4
    s_cbranch_vccz L_gtok_60
    s_sleep 32
    s_sub_u32 s62, s62, 1
    s_cmp_lg_u32 s62, 0
    s_cbranch_scc1 L_gt_59
    s_endpgm
L_gtok_60:
    v_mov_b32 v20, v172
    s_nop 1
    v_max_f32_dpp v20, v20, v20 quad_perm:[1,0,3,2] row_mask:0xf bank_mask:0xf
    s_nop 1
    v_max_f32_dpp v20, v20, v20 quad_perm:[2,3,0,1] row_mask:0xf bank_mask:0xf
    s_nop 1
    v_max_f32_dpp v20, v20, v20 row_half_mirror row_mask:0xf bank_mask:0xf
    v_sub_f32 v172, v172, v20
    v_mul_f32 v172, 0x3fb8aa3b, v172
    v_exp_f32 v172, v172
    s_nop 0
    v_mul_f32 v21, v172, v174
    s_nop 1
    v_add_f32_dpp v21, v21, v21 quad_perm:[1,0,3,2] row_mask:0xf bank_mask:0xf
    s_nop 1
    v_add_f32_dpp v21, v21, v21 quad_perm:[2,3,0,1] row_mask:0xf bank_mask:0xf
    s_nop 1
    v_add_f32_dpp v21, v21, v21 row_half_mirror row_mask:0xf bank_mask:0xf
    v_rcp_f32 v21, v21
    v_lshlrev_b32 v24, 16, v144
    v_and_b32 v25, 0xffff0000, v144
    v_lshlrev_b32 v26, 16, v145
    v_and_b32 v27, 0xffff0000, v145
    v_lshlrev_b32 v28, 16, v146
    v_and_b32 v29, 0xffff0000, v146
    v_lshlrev_b32 v30, 16, v147
    v_and_b32 v31, 0xffff0000, v147
    v_lshlrev_b32 v32, 16, v148
    v_and_b32 v33, 0xffff0000, v148
    v_lshlrev_b32 v34, 16, v149
    v_and_b32 v35, 0xffff0000, v149
    v_lshlrev_b32 v36, 16, v150
    v_and_b32 v37, 0xffff0000, v150
    v_lshlrev_b32 v38, 16, v151
    v_and_b32 v39, 0xffff0000, v151
    v_sub_f32 v24, v24, v20
    v_sub_f32 v25, v25, v20
    v_sub_f32 v26, v26, v20
    v_sub_f32 v27, v27, v20
    v_sub_f32 v28, v28, v20
    v_sub_f32 v29, v29, v20
    v_sub_f32 v30, v30, v20
    v_sub_f32 v31, v31, v20
    v_sub_f32 v32, v32, v20
    v_sub_f32 v33, v33, v20
    v_sub_f32 v34, v34, v20
    v_sub_f32 v35, v35, v20
    v_sub_f32 v36, v36, v20
    v_sub_f32 v37, v37, v20
    v_sub_f32 v38, v38, v20
    v_sub_f32 v39, v39, v20
    v_mul_f32 v24, 0x3fb8aa3b, v24
    v_mul_f32 v25, 0x3fb8aa3b, v25
    v_mul_f32 v26, 0x3fb8aa3b, v26
    v_mul_f32 v27, 0x3fb8aa3b, v27
    v_mul_f32 v28, 0x3fb8aa3b, v28
    v_mul_f32 v29, 0x3fb8aa3b, v29
    v_mul_f32 v30, 0x3fb8aa3b, v30
    v_mul_f32 v31, 0x3fb8aa3b, v31
    v_mul_f32 v32, 0x3fb8aa3b, v32
    v_mul_f32 v33, 0x3fb8aa3b, v33
    v_mul_f32 v34, 0x3fb8aa3b, v34
    v_mul_f32 v35, 0x3fb8aa3b, v35
    v_mul_f32 v36, 0x3fb8aa3b, v36
    v_mul_f32 v37, 0x3fb8aa3b, v37
    v_mul_f32 v38, 0x3fb8aa3b, v38
    v_mul_f32 v39, 0x3fb8aa3b, v39
    v_exp_f32 v24, v24
    v_exp_f32 v25, v25
    v_exp_f32 v26, v26
    v_exp_f32 v27, v27
    v_exp_f32 v28, v28
    v_exp_f32 v29, v29
    v_exp_f32 v30, v30
    v_exp_f32 v31, v31
    v_exp_f32 v32, v32
    v_exp_f32 v33, v33
    v_exp_f32 v34, v34
    v_exp_f32 v35, v35
    v_exp_f32 v36, v36
    v_exp_f32 v37, v37
    v_exp_f32 v38, v38
    v_exp_f32 v39, v39
    s_nop 0
    v_mul_f32 v24, v24, v21
    v_mul_f32 v25, v25, v21
    v_mul_f32 v26, v26, v21
    v_mul_f32 v27, v27, v21
    v_mul_f32 v28, v28, v21
    v_mul_f32 v29, v29, v21
    v_mul_f32 v30, v30, v21
    v_mul_f32 v31, v31, v21
    v_mul_f32 v32, v32, v21
    v_mul_f32 v33, v33, v21
    v_mul_f32 v34, v34, v21
    v_mul_f32 v35, v35, v21
    v_mul_f32 v36, v36, v21
    v_mul_f32 v37, v37, v21
    v_mul_f32 v38, v38, v21
    v_mul_f32 v39, v39, v21
    v_cvt_pk_bf16_f32 v144, v24, v25
    v_cvt_pk_bf16_f32 v145, v26, v27
    v_cvt_pk_bf16_f32 v146, v28, v29
    v_cvt_pk_bf16_f32 v147, v30, v31
    v_cvt_pk_bf16_f32 v148, v32, v33
    v_cvt_pk_bf16_f32 v149, v34, v35
    v_cvt_pk_bf16_f32 v150, v36, v37
    v_cvt_pk_bf16_f32 v151, v38, v39
    ds_write_b128 v22, v[144:147] offset:9728
    ds_write_b128 v22, v[148:151] offset:9744
    v_lshrrev_b32 v9, 4, v0
    v_lshlrev_b32 v9, 8, v9
    v_lshl_add_u32 v9, v2, 5, v9
    v_and_b32 v11, 1, v1
    v_lshl_add_u32 v9, v11, 4, v9
    v_lshrrev_b32 v10, 4, v0
    v_lshlrev_b32 v10, 13, v10
    v_and_b32 v11, 15, v0
    v_lshl_add_u32 v10, v11, 4, v10
    s_mul_i32 s52, s4, 270336
    s_lshl_b32 s7, s5, 8
    s_add_u32 s52, s52, s7
    s_add_u32 s52, s52, 917504
    s_mov_b32 s50, 1
    s_mov_b32 s51, 0
    s_mov_b32 s53, 0
    s_mov_b32 s54, s60
    s_cmp_lg_u32 s59, 0
    s_cselect_b32 s55, 73728, -1
    s_cselect_b32 s57, 3, 64
    s_lshl_b32 s58, s4, 8
    s_add_u32 s58, s58, 520192
    v_lshlrev_b32 v12, 2, v0
L_ha_dump:
    s_mov_b32 s62, 4000000
    v_mov_b32 v8, 0
L_wl_62:
    ds_read_b64 v[4:5], v8 offset:0
    s_waitcnt lgkmcnt(0)
    v_min_u32 v4, v4, v5
    s_nop 0
    v_readfirstlane_b32 s63, v4
    s_cmp_ge_u32 s63, s50
    s_cbranch_scc1 L_wlok_63
    s_sleep 2
    s_sub_u32 s62, s62, 1
    s_cmp_lg_u32 s62, 0
    s_cbranch_scc1 L_wl_62
    s_endpgm
L_wlok_63:
    v_add_u32 v11, s51, v9
    ds_read_b128 v[40:43], v11 offset:15872
    ds_read_b128 v[44:47], v11 offset:16640
    ds_read_b128 v[48:51], v11 offset:17408
    ds_read_b128 v[52:55], v11 offset:18176
    ds_read_b128 v[56:59], v11 offset:18944
    ds_read_b128 v[60:63], v11 offset:19712
    ds_read_b128 v[64:67], v11 offset:20480
    ds_read_b128 v[68:71], v11 offset:21248
    s_waitcnt lgkmcnt(7)
    ds_read_b128 v[72:75], v11 offset:22016
    ds_read_b128 v[76:79], v11 offset:22784
    ds_read_b128 v[80:83], v11 offset:23552
    ds_read_b128 v[84:87], v11 offset:24320
    ds_read_b128 v[88:91], v11 offset:25088
    ds_read_b128 v[92:95], v11 offset:25856
    ds_read_b128 v[96:99], v11 offset:26624
    ds_read_b128 v[100:103], v11 offset:27392
    s_waitcnt lgkmcnt(14)
    v_pk_add_f32 v[180:181], v[40:41], v[44:45]
    v_pk_add_f32 v[182:183], v[42:43], v[46:47]
    s_waitcnt lgkmcnt(13)
    v_pk_add_f32 v[180:181], v[180:181], v[48:49]
    v_pk_add_f32 v[182:183], v[182:183], v[50:51]
    s_waitcnt lgkmcnt(12)
    v_pk_add_f32 v[180:181], v[180:181], v[52:53]
    v_pk_add_f32 v[182:183], v[182:183], v[54:55]
    s_waitcnt lgkmcnt(11)
    v_pk_add_f32 v[180:181], v[180:181], v[56:57]
    v_pk_add_f32 v[182:183], v[182:183], v[58:59]
    s_waitcnt lgkmcnt(10)
    v_pk_add_f32 v[180:181], v[180:181], v[60:61]
    v_pk_add_f32 v[182:183], v[182:183], v[62:63]
    s_waitcnt lgkmcnt(9)
    v_pk_add_f32 v[180:181], v[180:181], v[64:65]
    v_pk_add_f32 v[182:183], v[182:183], v[66:67]
    s_waitcnt lgkmcnt(8)
    v_pk_add_f32 v[180:181], v[180:181], v[68:69]
    v_pk_add_f32 v[182:183], v[182:183], v[70:71]
    s_waitcnt lgkmcnt(7)
    v_pk_add_f32 v[180:181], v[180:181], v[72:73]
    v_pk_add_f32 v[182:183], v[182:183], v[74:75]
    s_waitcnt lgkmcnt(6)
    v_pk_add_f32 v[180:181], v[180:181], v[76:77]
    v_pk_add_f32 v[182:183], v[182:183], v[78:79]
    s_waitcnt lgkmcnt(5)
    v_pk_add_f32 v[180:181], v[180:181], v[80:81]
    v_pk_add_f32 v[182:183], v[182:183], v[82:83]
    s_waitcnt lgkmcnt(4)
    v_pk_add_f32 v[180:181], v[180:181], v[84:85]
    v_pk_add_f32 v[182:183], v[182:183], v[86:87]
    s_waitcnt lgkmcnt(3)
    v_pk_add_f32 v[180:181], v[180:181], v[88:89]
    v_pk_add_f32 v[182:183], v[182:183], v[90:91]
    s_waitcnt lgkmcnt(2)
    v_pk_add_f32 v[180:181], v[180:181], v[92:93]
    v_pk_add_f32 v[182:183], v[182:183], v[94:95]
    s_waitcnt lgkmcnt(1)
    v_pk_add_f32 v[180:181], v[180:181], v[96:97]
    v_pk_add_f32 v[182:183], v[182:183], v[98:99]
    s_waitcnt lgkmcnt(0)
    v_pk_add_f32 v[180:181], v[180:181], v[100:101]
    v_pk_add_f32 v[182:183], v[182:183], v[102:103]
    s_waitcnt lgkmcnt(0)
    v_mov_b32 v4, 52
    v_mov_b32 v5, s50
    ds_write_b32 v4, v5
    s_movk_i32 s61, 0xff
    v_bfe_u32 v14, s54, 0, 8
    v_bfe_u32 v15, s54, 8, 8
    v_bfe_u32 v16, s54, 16, 8
    v_bfe_u32 v17, s54, 24, 8
    v_bfi_b32 v180, s61, v14, v180
    v_bfi_b32 v181, s61, v15, v181
    v_bfi_b32 v182, s61, v16, v182
    v_bfi_b32 v183, s61, v17, v183
    s_cmp_le_u32 s50, s57
    s_cbranch_scc1 L_ha_free
    s_sub_u32 s6, s50, s57
    s_sub_u32 s7, s6, 3
    s_mul_i32 s7, s7, 3
    s_lshl_b32 s84, 7, s7
    s_cmp_lt_u32 s6, 3
    s_cselect_b32 s84, 0x3fffffff, s84
    s_min_u32 s6, s6, 3
    s_add_u32 s85, s6, s60
    s_sub_u32 s86, 3, s6
    s_mov_b32 s62, 400000
L_ha_wait:
    buffer_load_dword v4, v12, s[44:47], s58 offen sc1
    s_waitcnt vmcnt(0)
    v_subrev_u32 v4, s85, v4
    v_cmp_lt_u32 vcc, s86, v4
    s_nop 1
    s_and_b32 s6, vcc_lo, s84
    s_cbranch_scc0 L_ha_free
    s_sleep 4
    s_sub_u32 s62, s62, 1
    s_cmp_lg_u32 s62, 0
    s_cbranch_scc1 L_ha_wait
    s_endpgm
L_ha_free:
    s_add_u32 s6, s52, s53
    s_mov_b32 exec_hi, 0xffff
    s_cmp_lg_u32 s59, 0
    s_cbranch_scc1 L_ha_local
    buffer_store_dwordx4 v[180:183], v10, s[44:47], s6 offen sc1
    s_branch L_ha_stored
L_ha_local:
    buffer_store_dwordx4 v[180:183], v10, s[44:47], s6 offen
L_ha_stored:
    s_mov_b64 exec, -1
    s_add_u32 s53, s53, 24576
    s_cmp_eq_u32 s53, s55
    s_cselect_b32 s53, 0, s53
    s_add_u32 s54, s54, 0x1030507
    s_add_u32 s51, s51, 12288
    s_cmp_eq_u32 s51, 36864
    s_cselect_b32 s51, 0, s51
    s_add_u32 s50, s50, 1
    s_cmp_le_u32 s50, 10
    s_cbranch_scc1 L_ha_dump
    s_sub_u32 s56, s5, 29
    s_lshl_b32 s56, s56, 3
    s_add_u32 s56, s56, s4
    s_sub_u32 s6, s56, 8
    s_cmp_lt_u32 s6, 12
    s_cbranch_scc1 L_fin_entry
    s_endpgm
L_helperB:
    v_mul_u32_u24 v3, 0x2800, v1
    v_lshl_add_u32 v3, v2, 4, v3
    v_mov_b32 v4, 0
    v_mov_b32 v5, 0
    v_mov_b32 v6, 0
    v_mov_b32 v7, 0
    ds_write_b128 v4, v[4:7] offset:0
    ds_write_b128 v4, v[4:7] offset:16
    ds_write_b128 v4, v[4:7] offset:32
    ds_write_b128 v4, v[4:7] offset:48
    s_mul_i32 s43, s4, 245760
    s_mul_i32 s6, s41, 81920
    s_add_u32 s43, s43, s6
    s_lshl_b32 s6, s40, 7
    s_add_u32 s43, s43, s6
    s_waitcnt lgkmcnt(0)
    s_mov_b32 s12, s24
    s_mov_b32 s13, s25
    s_mov_b32 s14, 7864320
    s_mov_b32 s15, 0x20000
    s_barrier
    s_cmp_ge_u32 s5, 30
    s_cbranch_scc1 L_hb_tags
    s_add_u32 s42, s43, 3932160
    buffer_load_dwordx4 v[160:163], v3, s[12:15], s42 offen offset:0 nt
    buffer_load_dwordx4 v[164:167], v3, s[12:15], s42 offen offset:1280 nt
    buffer_load_dwordx4 v[168:171], v3, s[12:15], s42 offen offset:2560 nt
    buffer_load_dwordx4 v[172:175], v3, s[12:15], s42 offen offset:3840 nt
    s_add_u32 s42, s43, 3937280
    buffer_load_dwordx4 v[176:179], v3, s[12:15], s42 offen offset:0 nt
    buffer_load_dwordx4 v[180:183], v3, s[12:15], s42 offen offset:1280 nt
    buffer_load_dwordx4 v[184:187], v3, s[12:15], s42 offen offset:2560 nt
    buffer_load_dwordx4 v[188:191], v3, s[12:15], s42 offen offset:3840 nt
    s_add_u32 s42, s43, 5898240
    buffer_load_dwordx4 v[192:195], v3, s[12:15], s42 offen offset:0 nt
    buffer_load_dwordx4 v[196:199], v3, s[12:15], s42 offen offset:1280 nt
    buffer_load_dwordx4 v[200:203], v3, s[12:15], s42 offen offset:2560 nt
    buffer_load_dwordx4 v[204:207], v3, s[12:15], s42 offen offset:3840 nt
    s_add_u32 s42, s43, 5903360
    buffer_load_dwordx4 v[208:211], v3, s[12:15], s42 offen offset:0 nt
    buffer_load_dwordx4 v[212:215], v3, s[12:15], s42 offen offset:1280 nt
    buffer_load_dwordx4 v[216:219], v3, s[12:15], s42 offen offset:2560 nt
    buffer_load_dwordx4 v[220:223], v3, s[12:15], s42 offen offset:3840 nt
    s_mov_b32 s12, s32
    s_mov_b32 s13, s33
    s_mov_b32 s14, 1966080
    s_mov_b32 s15, 0x20000
    s_add_u32 s42, s43, 0
    buffer_load_dwordx4 v[224:227], v3, s[12:15], s42 offen offset:0 nt
    buffer_load_dwordx4 v[228:231], v3, s[12:15], s42 offen offset:1280 nt
    buffer_load_dwordx4 v[232:235], v3, s[12:15], s42 offen offset:2560 nt
    buffer_load_dwordx4 v[236:239], v3, s[12:15], s42 offen offset:3840 nt
    s_add_u32 s42, s43, 5120
    buffer_load_dwordx4 v[240:243], v3, s[12:15], s42 offen offset:0 nt
    buffer_load_dwordx4 v[244:247], v3, s[12:15], s42 offen offset:1280 nt
    s_waitcnt vmcnt(21)
    buffer_load_dwordx4 v[248:251], v3, s[12:15], s42 offen offset:2560 nt
    s_waitcnt vmcnt(21)
    buffer_load_dwordx4 v[252:255], v3, s[12:15], s42 offen offset:3840 nt
L_hb_tags:
    s_mov_b32 s8, s16
    s_mov_b32 s9, s17
    s_mov_b32 s10, 1280
    s_mov_b32 s11, 0x20000
    s_mov_b32 s44, s38
    s_mov_b32 s45, s39
    s_mov_b32 s46, 4194304
    s_mov_b32 s47, 0x20000
    s_mov_b32 s62, 4000000
    v_mov_b32 v8, 0
L_wl_64:
    ds_read_b32 v4, v8 offset:24
    s_waitcnt lgkmcnt(0)
    s_nop 0
    v_readfirstlane_b32 s63, v4
    s_cmp_ge_u32 s63, 1
    s_cbranch_scc1 L_wlok_65
    s_sleep 4
    s_sub_u32 s62, s62, 1
    s_cmp_lg_u32 s62, 0
    s_cbranch_scc1 L_wl_64
    s_endpgm
L_wlok_65:
    v_mov_b32 v8, 0
    ds_read_b32 v4, v8 offset:32
    s_waitcnt lgkmcnt(0)
    v_readfirstlane_b32 s60, v4
    s_nop 1
    s_movk_i32 s61, 0xff
    v_bfe_u32 v84, s60, 0, 8
    v_bfe_u32 v85, s60, 8, 8
    v_bfe_u32 v86, s60, 16, 8
    v_bfe_u32 v87, s60, 24, 8
    s_cmp_ge_u32 s5, 30
    s_cbranch_scc1 L_finisher
    v_lshrrev_b32 v92, 5, v0
    v_lshlrev_b32 v92, 7, v92
    v_lshl_add_u32 v92, v2, 4, v92
    s_mul_i32 s54, s40, 24
    s_mul_i32 s7, s4, 3
    s_add_u32 s54, s54, s7
    s_add_u32 s54, s54, s41
    s_lshl_b32 s54, s54, 8
    s_add_u32 s54, s54, 393216
    s_mov_b32 s48, 0x05040100
    s_mov_b32 s49, 0x07060302
    v_mov_b32 v12, -1
    v_mov_b32 v13, -1
    v_mov_b32 v14, -1
    v_mov_b32 v15, -1
    s_sub_u32 s6, s54, 65536
    s_mov_b32 exec_lo, 0xff
    s_mov_b32 exec_hi, 0xff
    buffer_store_dwordx4 v[12:15], v92, s[44:47], s6 offen sc1
    s_mov_b64 exec, -1
    s_mov_b32 s62, 4000000
    v_mov_b32 v8, 0
L_wl_66:
    ds_read_b32 v4, v8 offset:16
    s_waitcnt lgkmcnt(0)
    s_nop 0
    v_readfirstlane_b32 s63, v4
    s_cmp_ge_u32 s63, 2
    s_cbranch_scc1 L_wlok_67
    s_sleep 8
    s_sub_u32 s62, s62, 1
    s_cmp_lg_u32 s62, 0
    s_cbranch_scc1 L_wl_66
    s_endpgm
L_wlok_67:
    v_lshlrev_b32 v93, 4, v1
    v_and_b32 v88, 1, v2
    v_mul_u32_u24 v88, 7680, v88
    v_add_u32 v88, v88, v93
    s_mul_i32 s6, s4, 15360
    s_lshl_b32 s7, s41, 9
    s_add_u32 s6, s6, s7
    s_add_u32 s6, s6, 135680
    s_mov_b32 s62, 400000
L_gt_68:
    buffer_load_dwordx4 v[12:15], v88, s[44:47], s6 offen offset:0 sc1
    buffer_load_dwordx4 v[16:19], v88, s[44:47], s6 offen offset:128 sc1
    buffer_load_dwordx4 v[20:23], v88, s[44:47], s6 offen offset:256 sc1
    buffer_load_dwordx4 v[24:27], v88, s[44:47], s6 offen offset:384 sc1
    buffer_load_dwordx4 v[28:31], v88, s[44:47], s6 offen offset:1536 sc1
    buffer_load_dwordx4 v[32:35], v88, s[44:47], s6 offen offset:1664 sc1
    buffer_load_dwordx4 v[36:39], v88, s[44:47], s6 offen offset:1792 sc1
    buffer_load_dwordx4 v[40:43], v88, s[44:47], s6 offen offset:1920 sc1
L_gtmid_70:
    v_mov_b32 v4, 0
    v_mov_b32 v5, 0
    s_waitcnt vmcnt(0)
    v_bitop3_b32 v4, v4, v13, s60 bitop3:0xf6
    v_bitop3_b32 v4, v4, v15, s60 bitop3:0xf6
    v_bitop3_b32 v4, v4, v17, s60 bitop3:0xf6
    v_bitop3_b32 v4, v4, v19, s60 bitop3:0xf6
    v_bitop3_b32 v4, v4, v21, s60 bitop3:0xf6
    v_bitop3_b32 v4, v4, v23, s60 bitop3:0xf6
    v_bitop3_b32 v4, v4, v25, s60 bitop3:0xf6
    v_bitop3_b32 v4, v4, v27, s60 bitop3:0xf6
    v_bitop3_b32 v4, v4, v29, s60 bitop3:0xf6
    v_bitop3_b32 v4, v4, v31, s60 bitop3:0xf6
    v_bitop3_b32 v4, v4, v33, s60 bitop3:0xf6
    v_bitop3_b32 v4, v4, v35, s60 bitop3:0xf6
    v_bitop3_b32 v4, v4, v37, s60 bitop3:0xf6
    v_bitop3_b32 v4, v4, v39, s60 bitop3:0xf6
    v_bitop3_b32 v4, v4, v41, s60 bitop3:0xf6
    v_bitop3_b32 v4, v4, v43, s60 bitop3:0xf6
    v_cmp_ne_u32 vcc, 0, v4
    s_nop 4
    s_cbranch_vccz L_gtok_69
    s_sleep 32
    s_sub_u32 s62, s62, 1
    s_cmp_lg_u32 s62, 0
    s_cbranch_scc1 L_gt_68
    s_endpgm
L_gtok_69:
    v_add_f32_dpp v44, v12, v12 quad_perm:[1,0,3,2] row_mask:0xf bank_mask:0xf
    v_add_f32_dpp v45, v14, v14 quad_perm:[1,0,3,2] row_mask:0xf bank_mask:0xf
    v_add_f32_dpp v46, v16, v16 quad_perm:[1,0,3,2] row_mask:0xf bank_mask:0xf
    v_add_f32_dpp v47, v18, v18 quad_perm:[1,0,3,2] row_mask:0xf bank_mask:0xf
    v_add_f32_dpp v48, v20, v20 quad_perm:[1,0,3,2] row_mask:0xf bank_mask:0xf
    v_add_f32_dpp v49, v22, v22 quad_perm:[1,0,3,2] row_mask:0xf bank_mask:0xf
    v_add_f32_dpp v50, v24, v24 quad_perm:[1,0,3,2] row_mask:0xf bank_mask:0xf
    v_add_f32_dpp v51, v26, v26 quad_perm:[1,0,3,2] row_mask:0xf bank_mask:0xf
    v_add_f32_dpp v52, v28, v28 quad_perm:[1,0,3,2] row_mask:0xf bank_mask:0xf
    v_add_f32_dpp v53, v30, v30 quad_perm:[1,0,3,2] row_mask:0xf bank_mask:0xf
    v_add_f32_dpp v54, v32, v32 quad_perm:[1,0,3,2] row_mask:0xf bank_mask:0xf
    v_add_f32_dpp v55, v34, v34 quad_perm:[1,0,3,2] row_mask:0xf bank_mask:0xf
    v_add_f32_dpp v56, v36, v36 quad_perm:[1,0,3,2] row_mask:0xf bank_mask:0xf
    v_add_f32_dpp v57, v38, v38 quad_perm:[1,0,3,2] row_mask:0xf bank_mask:0xf
    v_add_f32_dpp v58, v40, v40 quad_perm:[1,0,3,2] row_mask:0xf bank_mask:0xf
    v_add_f32_dpp v59, v42, v42 quad_perm:[1,0,3,2] row_mask:0xf bank_mask:0xf
    v_cvt_pk_bf16_f32 v44, v44, v44
    v_and_b32 v44, 0xffff0000, v44
    v_cvt_pk_bf16_f32 v52, v52, v52
    v_and_b32 v52, 0xffff0000, v52
    v_cvt_pk_bf16_f32 v45, v45, v45
    v_and_b32 v45, 0xffff0000, v45
    v_cvt_pk_bf16_f32 v53, v53, v53
    v_and_b32 v53, 0xffff0000, v53
    v_cvt_pk_bf16_f32 v46, v46, v46
    v_and_b32 v46, 0xffff0000, v46
    v_cvt_pk_bf16_f32 v54, v54, v54
    v_and_b32 v54, 0xffff0000, v54
    v_cvt_pk_bf16_f32 v47, v47, v47
    v_and_b32 v47, 0xffff0000, v47
    v_cvt_pk_bf16_f32 v55, v55, v55
    v_and_b32 v55, 0xffff0000, v55
    v_cvt_pk_bf16_f32 v48, v48, v48
    v_and_b32 v48, 0xffff0000, v48
    v_cvt_pk_bf16_f32 v56, v56, v56
    v_and_b32 v56, 0xffff0000, v56
    v_cvt_pk_bf16_f32 v49, v49, v49
    v_and_b32 v49, 0xffff0000, v49
    v_cvt_pk_bf16_f32 v57, v57, v57
    v_and_b32 v57, 0xffff0000, v57
    v_cvt_pk_bf16_f32 v50, v50, v50
    v_and_b32 v50, 0xffff0000, v50
    v_cvt_pk_bf16_f32 v58, v58, v58
    v_and_b32 v58, 0xffff0000, v58
    v_cvt_pk_bf16_f32 v51, v51, v51
    v_and_b32 v51, 0xffff0000, v51
    v_cvt_pk_bf16_f32 v59, v59, v59
    v_and_b32 v59, 0xffff0000, v59
    s_mov_b32 s6, 0x3d372713
    v_mul_f32 v60, v44, v44
    v_mul_f32 v61, v45, v45
    v_mul_f32 v62, v46, v46
    v_mul_f32 v63, v47, v47
    v_mul_f32 v64, v48, v48
    v_mul_f32 v65, v49, v49
    v_mul_f32 v66, v50, v50
    v_mul_f32 v67, v51, v51
    v_mul_f32 v60, v60, v44
    v_mul_f32 v61, v61, v45
    v_mul_f32 v62, v62, v46
    v_mul_f32 v63, v63, v47
    v_mul_f32 v64, v64, v48
    v_mul_f32 v65, v65, v49
    v_mul_f32 v66, v66, v50
    v_mul_f32 v67, v67, v51
    v_fma_f32 v60, v60, s6, v44
    v_fma_f32 v61, v61, s6, v45
    v_fma_f32 v62, v62, s6, v46
    v_fma_f32 v63, v63, s6, v47
    v_fma_f32 v64, v64, s6, v48
    v_fma_f32 v65, v65, s6, v49
    v_fma_f32 v66, v66, s6, v50
    v_fma_f32 v67, v67, s6, v51
    v_mul_f32 v60, 0xc0135761, v60
    v_mul_f32 v61, 0xc0135761, v61
    v_mul_f32 v62, 0xc0135761, v62
    v_mul_f32 v63, 0xc0135761, v63
    v_mul_f32 v64, 0xc0135761, v64
    v_mul_f32 v65, 0xc0135761, v65
    v_mul_f32 v66, 0xc0135761, v66
    v_mul_f32 v67, 0xc0135761, v67
    v_exp_f32 v60, v60
    v_exp_f32 v61, v61
    v_exp_f32 v62, v62
    v_exp_f32 v63, v63
    v_exp_f32 v64, v64
    v_exp_f32 v65, v65
    v_exp_f32 v66, v66
    v_exp_f32 v67, v67
    v_add_f32 v60, 1.0, v60
    v_add_f32 v61, 1.0, v61
    v_add_f32 v62, 1.0, v62
    v_add_f32 v63, 1.0, v63
    v_add_f32 v64, 1.0, v64
    v_add_f32 v65, 1.0, v65
    v_add_f32 v66, 1.0, v66
    v_add_f32 v67, 1.0, v67
    v_rcp_f32 v60, v60
    v_rcp_f32 v61, v61
    v_rcp_f32 v62, v62
    v_rcp_f32 v63, v63
    v_rcp_f32 v64, v64
    v_rcp_f32 v65, v65
    v_rcp_f32 v66, v66
    v_rcp_f32 v67, v67
    v_mul_f32 v60, v60, v44
    v_mul_f32 v61, v61, v45
    v_mul_f32 v62, v62, v46
    v_mul_f32 v63, v63, v47
    v_mul_f32 v64, v64, v48
    v_mul_f32 v65, v65, v49
    v_mul_f32 v66, v66, v50
    v_mul_f32 v67, v67, v51
    v_cvt_pk_bf16_f32 v60, v60, v60
    v_and_b32 v60, 0xffff0000, v60
    v_cvt_pk_bf16_f32 v61, v61, v61
    v_and_b32 v61, 0xffff0000, v61
    v_cvt_pk_bf16_f32 v62, v62, v62
    v_and_b32 v62, 0xffff0000, v62
    v_cvt_pk_bf16_f32 v63, v63, v63
    v_and_b32 v63, 0xffff0000, v63
    v_cvt_pk_bf16_f32 v64, v64, v64
    v_and_b32 v64, 0xffff0000, v64
    v_cvt_pk_bf16_f32 v65, v65, v65
    v_and_b32 v65, 0xffff0000, v65
    v_cvt_pk_bf16_f32 v66, v66, v66
    v_and_b32 v66, 0xffff0000, v66
    v_cvt_pk_bf16_f32 v67, v67, v67
    v_and_b32 v67, 0xffff0000, v67
    v_mul_f32 v60, v60, v52
    v_mul_f32 v61, v61, v53
    v_mul_f32 v62, v62, v54
    v_mul_f32 v63, v63, v55
    v_mul_f32 v64, v64, v56
    v_mul_f32 v65, v65, v57
    v_mul_f32 v66, v66, v58
    v_mul_f32 v67, v67, v59
    v_cvt_pk_bf16_f32 v36, v60, v61
    v_cvt_pk_bf16_f32 v37, v62, v63
    v_cvt_pk_bf16_f32 v38, v64, v65
    v_cvt_pk_bf16_f32 v39, v66, v67
    v_perm_b32 v44, v228, v224, s48
    v_perm_b32 v45, v228, v224, s49
    v_perm_b32 v46, v229, v225, s48
    v_perm_b32 v47, v229, v225, s49
    v_perm_b32 v48, v230, v226, s48
    v_perm_b32 v49, v230, v226, s49
    v_perm_b32 v50, v231, v227, s48
    v_perm_b32 v51, v231, v227, s49
    v_perm_b32 v52, v236, v232, s48
    v_perm_b32 v53, v236, v232, s49
    v_perm_b32 v54, v237, v233, s48
    v_perm_b32 v55, v237, v233, s49
    v_perm_b32 v56, v238, v234, s48
    v_perm_b32 v57, v238, v234, s49
    v_perm_b32 v58, v239, v235, s48
    v_perm_b32 v59, v239, v235, s49
    v_perm_b32 v60, v244, v240, s48
    v_perm_b32 v61, v244, v240, s49
    v_perm_b32 v62, v245, v241, s48
    v_perm_b32 v63, v245, v241, s49
    v_perm_b32 v64, v246, v242, s48
    v_perm_b32 v65, v246, v242, s49
    v_perm_b32 v66, v247, v243, s48
    v_perm_b32 v67, v247, v243, s49
    v_perm_b32 v68, v252, v248, s48
    v_perm_b32 v69, v252, v248, s49
    v_perm_b32 v70, v253, v249, s48
    v_perm_b32 v71, v253, v249, s49
    v_perm_b32 v72, v254, v250, s48
    v_perm_b32 v73, v254, v250, s49
    v_perm_b32 v74, v255, v251, s48
    v_perm_b32 v75, v255, v251, s49
    v_mov_b32 v76, 0
    v_mov_b32 v77, 0
    v_mov_b32 v78, 0
    v_mov_b32 v79, 0
    v_mov_b32 v80, 0
    v_mov_b32 v81, 0
    v_mov_b32 v82, 0
    v_mov_b32 v83, 0
    v_lshl_add_u32 v93, v2, 8, v93
    v_add_u32 v94, 128, v93
    s_mul_i32 s55, s4, 270336
    s_lshl_b32 s7, s41, 13
    s_add_u32 s55, s55, s7
    s_add_u32 s55, s55, 917504
    s_mov_b32 s50, -1
    s_branch L_hb_gemv
L_hb_last:
    v_dot2c_f32_bf16 v76, v160, v224
    v_dot2c_f32_bf16 v77, v160, v225
    v_dot2c_f32_bf16 v78, v161, v224
    v_dot2c_f32_bf16 v79, v161, v225
    v_dot2c_f32_bf16 v80, v162, v224
    v_dot2c_f32_bf16 v81, v162, v225
    v_dot2c_f32_bf16 v82, v163, v224
    v_dot2c_f32_bf16 v83, v163, v225
    v_dot2c_f32_bf16 v76, v164, v226
    v_dot2c_f32_bf16 v77, v164, v227
    v_dot2c_f32_bf16 v78, v165, v226
    v_dot2c_f32_bf16 v79, v165, v227
    v_dot2c_f32_bf16 v80, v166, v226
    v_dot2c_f32_bf16 v81, v166, v227
    v_dot2c_f32_bf16 v82, v167, v226
    v_dot2c_f32_bf16 v83, v167, v227
    v_dot2c_f32_bf16 v76, v168, v228
    v_dot2c_f32_bf16 v77, v168, v229
    v_dot2c_f32_bf16 v78, v169, v228
    v_dot2c_f32_bf16 v79, v169, v229
    v_dot2c_f32_bf16 v80, v170, v228
    v_dot2c_f32_bf16 v81, v170, v229
    v_dot2c_f32_bf16 v82, v171, v228
    v_dot2c_f32_bf16 v83, v171, v229
    v_dot2c_f32_bf16 v76, v172, v230
    v_dot2c_f32_bf16 v77, v172, v231
    v_dot2c_f32_bf16 v78, v173, v230
    v_dot2c_f32_bf16 v79, v173, v231
    v_dot2c_f32_bf16 v80, v174, v230
    v_dot2c_f32_bf16 v81, v174, v231
    v_dot2c_f32_bf16 v82, v175, v230
    v_dot2c_f32_bf16 v83, v175, v231
    v_dot2c_f32_bf16 v76, v176, v232
    v_dot2c_f32_bf16 v77, v176, v233
    v_dot2c_f32_bf16 v78, v177, v232
    v_dot2c_f32_bf16 v79, v177, v233
    v_dot2c_f32_bf16 v80, v178, v232
    v_dot2c_f32_bf16 v81, v178, v233
    v_dot2c_f32_bf16 v82, v179, v232
    v_dot2c_f32_bf16 v83, v179, v233
    v_dot2c_f32_bf16 v76, v180, v234
    v_dot2c_f32_bf16 v77, v180, v235
    v_dot2c_f32_bf16 v78, v181, v234
    v_dot2c_f32_bf16 v79, v181, v235
    v_dot2c_f32_bf16 v80, v182, v234
    v_dot2c_f32_bf16 v81, v182, v235
    v_dot2c_f32_bf16 v82, v183, v234
    v_dot2c_f32_bf16 v83, v183, v235
    v_dot2c_f32_bf16 v76, v184, v236
    v_dot2c_f32_bf16 v77, v184, v237
    v_dot2c_f32_bf16 v78, v185, v236
    v_dot2c_f32_bf16 v79, v185, v237
    v_dot2c_f32_bf16 v80, v186, v236
    v_dot2c_f32_bf16 v81, v186, v237
    v_dot2c_f32_bf16 v82, v187, v236
    v_dot2c_f32_bf16 v83, v187, v237
    v_dot2c_f32_bf16 v76, v188, v238
    v_dot2c_f32_bf16 v77, v188, v239
    v_dot2c_f32_bf16 v78, v189, v238
    v_dot2c_f32_bf16 v79, v189, v239
    v_dot2c_f32_bf16 v80, v190, v238
    v_dot2c_f32_bf16 v81, v190, v239
    v_dot2c_f32_bf16 v82, v191, v238
    v_dot2c_f32_bf16 v83, v191, v239
    s_mov_b32 s12, s24
    s_mov_b32 s13, s25
    s_mov_b32 s14, 7864320
    s_mov_b32 s15, 0x20000
    v_lshlrev_b32 v93, 7, v1
    v_lshl_add_u32 v93, v2, 4, v93
    v_add_u32 v94, 1024, v93
    s_mov_b32 s62, 4000000
    v_mov_b32 v8, 0
L_wl_71:
    ds_read_b64 v[4:5], v8 offset:8
    s_waitcnt lgkmcnt(0)
    v_min_u32 v4, v4, v5
    s_nop 0
    v_readfirstlane_b32 s63, v4
    s_cmp_ge_u32 s63, 64
    s_cbranch_scc1 L_wlok_72
    s_sleep 1
    s_sub_u32 s62, s62, 1
    s_cmp_lg_u32 s62, 0
    s_cbranch_scc1 L_wl_71
    s_endpgm
L_wlok_72:
    s_add_u32 s42, s43, 0
    buffer_load_dwordx4 v[96:99], v3, s[12:15], s42 offen offset:0 nt
    buffer_load_dwordx4 v[100:103], v3, s[12:15], s42 offen offset:1280 nt
    buffer_load_dwordx4 v[104:107], v3, s[12:15], s42 offen offset:2560 nt
    buffer_load_dwordx4 v[108:111], v3, s[12:15], s42 offen offset:3840 nt
    s_add_u32 s42, s43, 5120
    buffer_load_dwordx4 v[112:115], v3, s[12:15], s42 offen offset:0 nt
    buffer_load_dwordx4 v[116:119], v3, s[12:15], s42 offen offset:1280 nt
    buffer_load_dwordx4 v[120:123], v3, s[12:15], s42 offen offset:2560 nt
    buffer_load_dwordx4 v[124:127], v3, s[12:15], s42 offen offset:3840 nt
    s_add_u32 s42, s43, 1966080
    buffer_load_dwordx4 v[128:131], v3, s[12:15], s42 offen offset:0 nt
    buffer_load_dwordx4 v[132:135], v3, s[12:15], s42 offen offset:1280 nt
    buffer_load_dwordx4 v[136:139], v3, s[12:15], s42 offen offset:2560 nt
    buffer_load_dwordx4 v[140:143], v3, s[12:15], s42 offen offset:3840 nt
    s_add_u32 s42, s43, 1971200
    buffer_load_dwordx4 v[144:147], v3, s[12:15], s42 offen offset:0 nt
    buffer_load_dwordx4 v[148:151], v3, s[12:15], s42 offen offset:1280 nt
    buffer_load_dwordx4 v[152:155], v3, s[12:15], s42 offen offset:2560 nt
    buffer_load_dwordx4 v[156:159], v3, s[12:15], s42 offen offset:3840 nt
    s_waitcnt vmcnt(15)
    v_dot2c_f32_bf16 v76, v96, v192
    v_dot2c_f32_bf16 v77, v96, v193
    v_dot2c_f32_bf16 v78, v97, v192
    v_dot2c_f32_bf16 v79, v97, v193
    v_dot2c_f32_bf16 v80, v98, v192
    v_dot2c_f32_bf16 v81, v98, v193
    v_dot2c_f32_bf16 v82, v99, v192
    v_dot2c_f32_bf16 v83, v99, v193
    s_waitcnt vmcnt(14)
    v_dot2c_f32_bf16 v76, v100, v194
    v_dot2c_f32_bf16 v77, v100, v195
    v_dot2c_f32_bf16 v78, v101, v194
    v_dot2c_f32_bf16 v79, v101, v195
    v_dot2c_f32_bf16 v80, v102, v194
    v_dot2c_f32_bf16 v81, v102, v195
    v_dot2c_f32_bf16 v82, v103, v194
    v_dot2c_f32_bf16 v83, v103, v195
    s_waitcnt vmcnt(13)
    v_dot2c_f32_bf16 v76, v104, v196
    v_dot2c_f32_bf16 v77, v104, v197
    v_dot2c_f32_bf16 v78, v105, v196
    v_dot2c_f32_bf16 v79, v105, v197
    v_dot2c_f32_bf16 v80, v106, v196
    v_dot2c_f32_bf16 v81, v106, v197
    v_dot2c_f32_bf16 v82, v107, v196
    v_dot2c_f32_bf16 v83, v107, v197
    s_waitcnt vmcnt(12)
    v_dot2c_f32_bf16 v76, v108, v198
    v_dot2c_f32_bf16 v77, v108, v199
    v_dot2c_f32_bf16 v78, v109, v198
    v_dot2c_f32_bf16 v79, v109, v199
    v_dot2c_f32_bf16 v80, v110, v198
    v_dot2c_f32_bf16 v81, v110, v199
    v_dot2c_f32_bf16 v82, v111, v198
    v_dot2c_f32_bf16 v83, v111, v199
    s_waitcnt vmcnt(11)
    v_dot2c_f32_bf16 v76, v112, v200
    v_dot2c_f32_bf16 v77, v112, v201
    v_dot2c_f32_bf16 v78, v113, v200
    v_dot2c_f32_bf16 v79, v113, v201
    v_dot2c_f32_bf16 v80, v114, v200
    v_dot2c_f32_bf16 v81, v114, v201
    v_dot2c_f32_bf16 v82, v115, v200
    v_dot2c_f32_bf16 v83, v115, v201
    s_waitcnt vmcnt(10)
    v_dot2c_f32_bf16 v76, v116, v202
    v_dot2c_f32_bf16 v77, v116, v203
    v_dot2c_f32_bf16 v78, v117, v202
    v_dot2c_f32_bf16 v79, v117, v203
    v_dot2c_f32_bf16 v80, v118, v202
    v_dot2c_f32_bf16 v81, v118, v203
    v_dot2c_f32_bf16 v82, v119, v202
    v_dot2c_f32_bf16 v83, v119, v203
    s_waitcnt vmcnt(9)
    v_dot2c_f32_bf16 v76, v120, v204
    v_dot2c_f32_bf16 v77, v120, v205
    v_dot2c_f32_bf16 v78, v121, v204
    v_dot2c_f32_bf16 v79, v121, v205
    v_dot2c_f32_bf16 v80, v122, v204
    v_dot2c_f32_bf16 v81, v122, v205
    v_dot2c_f32_bf16 v82, v123, v204
    v_dot2c_f32_bf16 v83, v123, v205
    s_waitcnt vmcnt(8)
    v_dot2c_f32_bf16 v76, v124, v206
    v_dot2c_f32_bf16 v77, v124, v207
    v_dot2c_f32_bf16 v78, v125, v206
    v_dot2c_f32_bf16 v79, v125, v207
    v_dot2c_f32_bf16 v80, v126, v206
    v_dot2c_f32_bf16 v81, v126, v207
    v_dot2c_f32_bf16 v82, v127, v206
    v_dot2c_f32_bf16 v83, v127, v207
    s_waitcnt vmcnt(7)
    v_dot2c_f32_bf16 v76, v128, v208
    v_dot2c_f32_bf16 v77, v128, v209
    v_dot2c_f32_bf16 v78, v129, v208
    v_dot2c_f32_bf16 v79, v129, v209
    v_dot2c_f32_bf16 v80, v130, v208
    v_dot2c_f32_bf16 v81, v130, v209
    v_dot2c_f32_bf16 v82, v131, v208
    v_dot2c_f32_bf16 v83, v131, v209
    s_waitcnt vmcnt(6)
    v_dot2c_f32_bf16 v76, v132, v210
    v_dot2c_f32_bf16 v77, v132, v211
    v_dot2c_f32_bf16 v78, v133, v210
    v_dot2c_f32_bf16 v79, v133, v211
    v_dot2c_f32_bf16 v80, v134, v210
    v_dot2c_f32_bf16 v81, v134, v211
    v_dot2c_f32_bf16 v82, v135, v210
    v_dot2c_f32_bf16 v83, v135, v211
    s_waitcnt vmcnt(5)
    v_dot2c_f32_bf16 v76, v136, v212
    v_dot2c_f32_bf16 v77, v136, v213
    v_dot2c_f32_bf16 v78, v137, v212
    v_dot2c_f32_bf16 v79, v137, v213
    v_dot2c_f32_bf16 v80, v138, v212
    v_dot2c_f32_bf16 v81, v138, v213
    v_dot2c_f32_bf16 v82, v139, v212
    v_dot2c_f32_bf16 v83, v139, v213
    s_waitcnt vmcnt(4)
    v_dot2c_f32_bf16 v76, v140, v214
    v_dot2c_f32_bf16 v77, v140, v215
    v_dot2c_f32_bf16 v78, v141, v214
    v_dot2c_f32_bf16 v79, v141, v215
    v_dot2c_f32_bf16 v80, v142, v214
    v_dot2c_f32_bf16 v81, v142, v215
    v_dot2c_f32_bf16 v82, v143, v214
    v_dot2c_f32_bf16 v83, v143, v215
    s_add_u32 s53, s52, 4096
    s_mov_b32 s62, 400000
    buffer_load_dwordx4 v[96:99], v93, s[44:47], s52 offen offset:0 sc1
    buffer_load_dwordx4 v[100:103], v94, s[44:47], s52 offen offset:0 sc1
    buffer_load_dwordx4 v[104:107], v93, s[44:47], s52 offen offset:2048 sc1
    buffer_load_dwordx4 v[108:111], v94, s[44:47], s52 offen offset:2048 sc1
    buffer_load_dwordx4 v[112:115], v93, s[44:47], s53 offen offset:0 sc1
    buffer_load_dwordx4 v[116:119], v94, s[44:47], s53 offen offset:0 sc1
    buffer_load_dwordx4 v[120:123], v93, s[44:47], s53 offen offset:2048 sc1
    buffer_load_dwordx4 v[124:127], v94, s[44:47], s53 offen offset:2048 sc1
    s_waitcnt vmcnt(11)
    v_dot2c_f32_bf16 v76, v144, v216
    v_dot2c_f32_bf16 v77, v144, v217
    v_dot2c_f32_bf16 v78, v145, v216
    v_dot2c_f32_bf16 v79, v145, v217
    v_dot2c_f32_bf16 v80, v146, v216
    v_dot2c_f32_bf16 v81, v146, v217
    v_dot2c_f32_bf16 v82, v147, v216
    v_dot2c_f32_bf16 v83, v147, v217
    s_waitcnt vmcnt(10)
    v_dot2c_f32_bf16 v76, v148, v218
    v_dot2c_f32_bf16 v77, v148, v219
    v_dot2c_f32_bf16 v78, v149, v218
    v_dot2c_f32_bf16 v79, v149, v219
    v_dot2c_f32_bf16 v80, v150, v218
    v_dot2c_f32_bf16 v81, v150, v219
    v_dot2c_f32_bf16 v82, v151, v218
    v_dot2c_f32_bf16 v83, v151, v219
    s_waitcnt vmcnt(9)
    v_dot2c_f32_bf16 v76, v152, v220
    v_dot2c_f32_bf16 v77, v152, v221
    v_dot2c_f32_bf16 v78, v153, v220
    v_dot2c_f32_bf16 v79, v153, v221
    v_dot2c_f32_bf16 v80, v154, v220
    v_dot2c_f32_bf16 v81, v154, v221
    v_dot2c_f32_bf16 v82, v155, v220
    v_dot2c_f32_bf16 v83, v155, v221
    s_waitcnt vmcnt(8)
    v_dot2c_f32_bf16 v76, v156, v222
    v_dot2c_f32_bf16 v77, v156, v223
    v_dot2c_f32_bf16 v78, v157, v222
    v_dot2c_f32_bf16 v79, v157, v223
    v_dot2c_f32_bf16 v80, v158, v222
    v_dot2c_f32_bf16 v81, v158, v223
    v_dot2c_f32_bf16 v82, v159, v222
    v_dot2c_f32_bf16 v83, v159, v223
    buffer_load_dwordx4 v[160:163], v93, s[44:47], s52 offen offset:0 sc1
    buffer_load_dwordx4 v[164:167], v94, s[44:47], s52 offen offset:0 sc1
    buffer_load_dwordx4 v[168:171], v93, s[44:47], s52 offen offset:2048 sc1
    buffer_load_dwordx4 v[172:175], v94, s[44:47], s52 offen offset:2048 sc1
    buffer_load_dwordx4 v[176:179], v93, s[44:47], s53 offen offset:0 sc1
    buffer_load_dwordx4 v[180:183], v94, s[44:47], s53 offen offset:0 sc1
    buffer_load_dwordx4 v[184:187], v93, s[44:47], s53 offen offset:2048 sc1
    buffer_load_dwordx4 v[188:191], v94, s[44:47], s53 offen offset:2048 sc1
L_hb_poll:
    s_waitcnt vmcnt(8)
    v_max_u32 v4, v96, v97
    v_max3_u32 v4, v4, v98, v99
    v_max3_u32 v4, v4, v100, v101
    v_max3_u32 v4, v4, v102, v103
    v_max3_u32 v4, v4, v104, v105
    v_max3_u32 v4, v4, v106, v107
    v_max3_u32 v4, v4, v108, v109
    v_max3_u32 v4, v4, v110, v111
    v_max3_u32 v4, v4, v112, v113
    v_max3_u32 v4, v4, v114, v115
    v_max3_u32 v4, v4, v116, v117
    v_max3_u32 v4, v4, v118, v119
    v_max3_u32 v4, v4, v120, v121
    v_max3_u32 v4, v4, v122, v123
    v_max3_u32 v4, v4, v124, v125
    v_max3_u32 v4, v4, v126, v127
    v_cmp_eq_u32 vcc, -1, v4
    v_pk_add_f32 v[12:13], v[96:97], v[104:105]
    v_pk_add_f32 v[14:15], v[98:99], v[106:107]
    v_pk_add_f32 v[16:17], v[100:101], v[108:109]
    v_pk_add_f32 v[18:19], v[102:103], v[110:111]
    v_pk_add_f32 v[112:113], v[112:113], v[120:121]
    v_pk_add_f32 v[114:115], v[114:115], v[122:123]
    v_pk_add_f32 v[116:117], v[116:117], v[124:125]
    v_pk_add_f32 v[118:119], v[118:119], v[126:127]
    v_pk_add_f32 v[12:13], v[12:13], v[112:113]
    v_pk_add_f32 v[14:15], v[14:15], v[114:115]
    v_pk_add_f32 v[16:17], v[16:17], v[116:117]
    v_pk_add_f32 v[18:19], v[18:19], v[118:119]
    s_cbranch_vccz L_hb_summed
    buffer_load_dwordx4 v[96:99], v93, s[44:47], s52 offen offset:0 sc1
    buffer_load_dwordx4 v[100:103], v94, s[44:47], s52 offen offset:0 sc1
    buffer_load_dwordx4 v[104:107], v93, s[44:47], s52 offen offset:2048 sc1
    buffer_load_dwordx4 v[108:111], v94, s[44:47], s52 offen offset:2048 sc1
    buffer_load_dwordx4 v[112:115], v93, s[44:47], s53 offen offset:0 sc1
    buffer_load_dwordx4 v[116:119], v94, s[44:47], s53 offen offset:0 sc1
    buffer_load_dwordx4 v[120:123], v93, s[44:47], s53 offen offset:2048 sc1
    buffer_load_dwordx4 v[124:127], v94, s[44:47], s53 offen offset:2048 sc1
    s_waitcnt vmcnt(8)
    v_max_u32 v4, v160, v161
    v_max3_u32 v4, v4, v162, v163
    v_max3_u32 v4, v4, v164, v165
    v_max3_u32 v4, v4, v166, v167
    v_max3_u32 v4, v4, v168, v169
    v_max3_u32 v4, v4, v170, v171
    v_max3_u32 v4, v4, v172, v173
    v_max3_u32 v4, v4, v174, v175
    v_max3_u32 v4, v4, v176, v177
    v_max3_u32 v4, v4, v178, v179
    v_max3_u32 v4, v4, v180, v181
    v_max3_u32 v4, v4, v182, v183
    v_max3_u32 v4, v4, v184, v185
    v_max3_u32 v4, v4, v186, v187
    v_max3_u32 v4, v4, v188, v189
    v_max3_u32 v4, v4, v190, v191
    v_cmp_eq_u32 vcc, -1, v4
    v_pk_add_f32 v[12:13], v[160:161], v[168:169]
    v_pk_add_f32 v[14:15], v[162:163], v[170:171]
    v_pk_add_f32 v[16:17], v[164:165], v[172:173]
    v_pk_add_f32 v[18:19], v[166:167], v[174:175]
    v_pk_add_f32 v[176:177], v[176:177], v[184:185]
    v_pk_add_f32 v[178:179], v[178:179], v[186:187]
    v_pk_add_f32 v[180:181], v[180:181], v[188:189]
    v_pk_add_f32 v[182:183], v[182:183], v[190:191]
    v_pk_add_f32 v[12:13], v[12:13], v[176:177]
    v_pk_add_f32 v[14:15], v[14:15], v[178:179]
    v_pk_add_f32 v[16:17], v[16:17], v[180:181]
    v_pk_add_f32 v[18:19], v[18:19], v[182:183]
    s_cbranch_vccz L_hb_summed
    buffer_load_dwordx4 v[160:163], v93, s[44:47], s52 offen offset:0 sc1
    buffer_load_dwordx4 v[164:167], v94, s[44:47], s52 offen offset:0 sc1
    buffer_load_dwordx4 v[168:171], v93, s[44:47], s52 offen offset:2048 sc1
    buffer_load_dwordx4 v[172:175], v94, s[44:47], s52 offen offset:2048 sc1
    buffer_load_dwordx4 v[176:179], v93, s[44:47], s53 offen offset:0 sc1
    buffer_load_dwordx4 v[180:183], v94, s[44:47], s53 offen offset:0 sc1
    buffer_load_dwordx4 v[184:187], v93, s[44:47], s53 offen offset:2048 sc1
    buffer_load_dwordx4 v[188:191], v94, s[44:47], s53 offen offset:2048 sc1
    s_sub_u32 s62, s62, 1
    s_cmp_lg_u32 s62, 0
    s_cbranch_scc1 L_hb_poll
    s_endpgm
L_hb_gather:
    ds_read_b32 v4, v8 offset:48
    s_mul_i32 s6, s51, 0x1030507
    s_add_u32 s6, s6, s60
    s_movk_i32 s61, 0xff
    v_bfe_u32 v88, s6, 0, 8
    v_bfe_u32 v89, s6, 8, 8
    v_bfe_u32 v90, s6, 16, 8
    v_bfe_u32 v91, s6, 24, 8
    s_waitcnt lgkmcnt(0)
    v_readfirstlane_b32 s59, v4
    s_mov_b32 s6, s51
    s_sub_u32 s7, s6, 3
    s_cmp_ge_u32 s6, 3
    s_cselect_b32 s6, s7, s6
    s_sub_u32 s7, s6, 3
    s_cmp_ge_u32 s6, 3
    s_cselect_b32 s6, s7, s6
    s_sub_u32 s7, s6, 3
    s_cmp_ge_u32 s6, 3
    s_cselect_b32 s6, s7, s6
    s_cmp_lg_u32 s59, 0
    s_cselect_b32 s6, s6, s51
    s_mul_i32 s52, s6, 24576
    s_add_u32 s52, s52, s55
    s_add_u32 s53, s52, 4096
    s_mov_b32 s62, 400000
    s_mov_b32 s84, -1
    s_mov_b32 s85, 0xffffffff
    s_mov_b32 s86, -1
    s_mov_b32 s87, 0xffffffff
    s_mov_b32 s88, -1
    s_mov_b32 s89, 0xffffffff
    s_mov_b32 s90, -1
    s_mov_b32 s91, 0xffffffff
L_ge_73:
    s_mov_b64 exec, s[84:85]
    s_cbranch_execz L_gs_76
    buffer_load_dwordx4 v[12:15], v93, s[44:47], s52 offen offset:0 sc1
    buffer_load_dwordx4 v[16:19], v94, s[44:47], s52 offen offset:0 sc1
L_gs_76:
    s_mov_b64 exec, s[86:87]
    s_cbranch_execz L_gs_77
    buffer_load_dwordx4 v[20:23], v93, s[44:47], s52 offen offset:2048 sc1
    buffer_load_dwordx4 v[24:27], v94, s[44:47], s52 offen offset:2048 sc1
L_gs_77:
    s_mov_b64 exec, s[88:89]
    s_cbranch_execz L_gs_78
    buffer_load_dwordx4 v[28:31], v93, s[44:47], s53 offen offset:0 sc1
    buffer_load_dwordx4 v[32:35], v94, s[44:47], s53 offen offset:0 sc1
L_gs_78:
    s_mov_b64 exec, s[90:91]
    s_cbranch_execz L_gs_79
    buffer_load_dwordx4 v[36:39], v93, s[44:47], s53 offen offset:2048 sc1
    buffer_load_dwordx4 v[40:43], v94, s[44:47], s53 offen offset:2048 sc1
L_gs_79:
L_gemid_75:
    s_mov_b64 vcc, 0
    s_waitcnt vmcnt(0)
    s_mov_b64 exec, s[84:85]
    s_cbranch_execz L_gs_80
    v_xor_b32 v12, v12, v88
    v_xor_b32 v13, v13, v89
    v_xor_b32 v14, v14, v90
    v_xor_b32 v15, v15, v91
    v_xor_b32 v16, v16, v88
    v_xor_b32 v17, v17, v89
    v_xor_b32 v18, v18, v90
    v_xor_b32 v19, v19, v91
    v_or_b32 v4, v12, v13
    v_or3_b32 v4, v4, v14, v15
    v_or3_b32 v4, v4, v16, v17
    v_or3_b32 v4, v4, v18, v19
    v_and_b32 v4, s61, v4
    v_cmp_ne_u32 s[84:85], 0, v4
    s_nop 0
    s_or_b64 vcc, vcc, s[84:85]
L_gs_80:
    s_mov_b64 exec, s[86:87]
    s_cbranch_execz L_gs_81
    v_xor_b32 v20, v20, v88
    v_xor_b32 v21, v21, v89
    v_xor_b32 v22, v22, v90
    v_xor_b32 v23, v23, v91
    v_xor_b32 v24, v24, v88
    v_xor_b32 v25, v25, v89
    v_xor_b32 v26, v26, v90
    v_xor_b32 v27, v27, v91
    v_or_b32 v4, v20, v21
    v_or3_b32 v4, v4, v22, v23
    v_or3_b32 v4, v4, v24, v25
    v_or3_b32 v4, v4, v26, v27
    v_and_b32 v4, s61, v4
    v_cmp_ne_u32 s[86:87], 0, v4
    s_nop 0
    s_or_b64 vcc, vcc, s[86:87]
L_gs_81:
    s_mov_b64 exec, s[88:89]
    s_cbranch_execz L_gs_82
    v_xor_b32 v28, v28, v88
    v_xor_b32 v29, v29, v89
    v_xor_b32 v30, v30, v90
    v_xor_b32 v31, v31, v91
    v_xor_b32 v32, v32, v88
    v_xor_b32 v33, v33, v89
    v_xor_b32 v34, v34, v90
    v_xor_b32 v35, v35, v91
    v_or_b32 v4, v28, v29
    v_or3_b32 v4, v4, v30, v31
    v_or3_b32 v4, v4, v32, v33
    v_or3_b32 v4, v4, v34, v35
    v_and_b32 v4, s61, v4
    v_cmp_ne_u32 s[88:89], 0, v4
    s_nop 0
    s_or_b64 vcc, vcc, s[88:89]
L_gs_82:
    s_mov_b64 exec, s[90:91]
    s_cbranch_execz L_gs_83
    v_xor_b32 v36, v36, v88
    v_xor_b32 v37, v37, v89
    v_xor_b32 v38, v38, v90
    v_xor_b32 v39, v39, v91
    v_xor_b32 v40, v40, v88
    v_xor_b32 v41, v41, v89
    v_xor_b32 v42, v42, v90
    v_xor_b32 v43, v43, v91
    v_or_b32 v4, v36, v37
    v_or3_b32 v4, v4, v38, v39
    v_or3_b32 v4, v4, v40, v41
    v_or3_b32 v4, v4, v42, v43
    v_and_b32 v4, s61, v4
    v_cmp_ne_u32 s[90:91], 0, v4
    s_nop 0
    s_or_b64 vcc, vcc, s[90:91]
L_gs_83:
    s_mov_b64 exec, -1
    s_cmp_eq_u64 vcc, 0
    s_cbranch_scc1 L_geok_74
    s_sleep 16
    s_sub_u32 s62, s62, 1
    s_cmp_lg_u32 s62, 0
    s_cbranch_scc1 L_ge_73
    s_endpgm
L_geok_74:
    s_min_u32 s6, s51, 2
    s_add_u32 s6, s6, s60
    s_add_u32 s6, s6, 1
    v_mov_b32 v4, s6
    s_lshl_b32 s6, s4, 8
    s_lshl_b32 s7, s5, 2
    s_add_u32 s6, s6, s7
    s_add_u32 s6, s6, 520192
    s_mov_b64 exec, 1
    buffer_store_dword v4, v8, s[44:47], s6 offen
    s_mov_b64 exec, -1
    v_pk_add_f32 v[12:13], v[12:13], v[20:21]
    v_pk_add_f32 v[14:15], v[14:15], v[22:23]
    v_pk_add_f32 v[16:17], v[16:17], v[24:25]
    v_pk_add_f32 v[18:19], v[18:19], v[26:27]
    v_pk_add_f32 v[28:29], v[28:29], v[36:37]
    v_pk_add_f32 v[30:31], v[30:31], v[38:39]
    v_pk_add_f32 v[32:33], v[32:33], v[40:41]
    v_pk_add_f32 v[34:35], v[34:35], v[42:43]
    v_pk_add_f32 v[12:13], v[12:13], v[28:29]
    v_pk_add_f32 v[14:15], v[14:15], v[30:31]
    v_pk_add_f32 v[16:17], v[16:17], v[32:33]
    v_pk_add_f32 v[18:19], v[18:19], v[34:35]
L_hb_summed:
    v_add_f32_dpp v12, v12, v12 quad_perm:[1,0,3,2] row_mask:0xf bank_mask:0xf
    v_add_f32_dpp v13, v13, v13 quad_perm:[1,0,3,2] row_mask:0xf bank_mask:0xf
    v_add_f32_dpp v14, v14, v14 quad_perm:[1,0,3,2] row_mask:0xf bank_mask:0xf
    v_add_f32_dpp v15, v15, v15 quad_perm:[1,0,3,2] row_mask:0xf bank_mask:0xf
    v_add_f32_dpp v16, v16, v16 quad_perm:[1,0,3,2] row_mask:0xf bank_mask:0xf
    v_add_f32_dpp v17, v17, v17 quad_perm:[1,0,3,2] row_mask:0xf bank_mask:0xf
    v_add_f32_dpp v18, v18, v18 quad_perm:[1,0,3,2] row_mask:0xf bank_mask:0xf
    v_add_f32_dpp v19, v19, v19 quad_perm:[1,0,3,2] row_mask:0xf bank_mask:0xf
    v_add_f32_dpp v12, v12, v12 quad_perm:[2,3,0,1] row_mask:0xf bank_mask:0xf
    v_add_f32_dpp v13, v13, v13 quad_perm:[2,3,0,1] row_mask:0xf bank_mask:0xf
    v_add_f32_dpp v14, v14, v14 quad_perm:[2,3,0,1] row_mask:0xf bank_mask:0xf
    v_add_f32_dpp v15, v15, v15 quad_perm:[2,3,0,1] row_mask:0xf bank_mask:0xf
    v_add_f32_dpp v16, v16, v16 quad_perm:[2,3,0,1] row_mask:0xf bank_mask:0xf
    v_add_f32_dpp v17, v17, v17 quad_perm:[2,3,0,1] row_mask:0xf bank_mask:0xf
    v_add_f32_dpp v18, v18, v18 quad_perm:[2,3,0,1] row_mask:0xf bank_mask:0xf
    v_add_f32_dpp v19, v19, v19 quad_perm:[2,3,0,1] row_mask:0xf bank_mask:0xf
    v_add_f32_dpp v12, v12, v12 row_half_mirror row_mask:0xf bank_mask:0xf
    v_add_f32_dpp v13, v13, v13 row_half_mirror row_mask:0xf bank_mask:0xf
    v_add_f32_dpp v14, v14, v14 row_half_mirror row_mask:0xf bank_mask:0xf
    v_add_f32_dpp v15, v15, v15 row_half_mirror row_mask:0xf bank_mask:0xf
    v_add_f32_dpp v16, v16, v16 row_half_mirror row_mask:0xf bank_mask:0xf
    v_add_f32_dpp v17, v17, v17 row_half_mirror row_mask:0xf bank_mask:0xf
    v_add_f32_dpp v18, v18, v18 row_half_mirror row_mask:0xf bank_mask:0xf
    v_add_f32_dpp v19, v19, v19 row_half_mirror row_mask:0xf bank_mask:0xf
    v_cvt_pk_bf16_f32 v36, v12, v13
    v_cvt_pk_bf16_f32 v37, v14, v15
    v_cvt_pk_bf16_f32 v38, v16, v17
    v_cvt_pk_bf16_f32 v39, v18, v19
    s_cmp_lg_u32 s50, 3
    s_cbranch_scc1 L_hb_keep
L_hb_gemv:
    v_dot2c_f32_bf16 v76, v44, v36
    v_dot2c_f32_bf16 v77, v45, v36
    v_dot2c_f32_bf16 v78, v46, v36
    v_dot2c_f32_bf16 v79, v47, v36
    v_dot2c_f32_bf16 v80, v48, v36
    v_dot2c_f32_bf16 v81, v49, v36
    v_dot2c_f32_bf16 v82, v50, v36
    v_dot2c_f32_bf16 v83, v51, v36
    v_dot2c_f32_bf16 v76, v52, v37
    v_dot2c_f32_bf16 v77, v53, v37
    v_dot2c_f32_bf16 v78, v54, v37
    v_dot2c_f32_bf16 v79, v55, v37
    v_dot2c_f32_bf16 v80, v56, v37
    v_dot2c_f32_bf16 v81, v57, v37
    v_dot2c_f32_bf16 v82, v58, v37
    v_dot2c_f32_bf16 v83, v59, v37
    v_dot2c_f32_bf16 v76, v60, v38
    v_dot2c_f32_bf16 v77, v61, v38
    v_dot2c_f32_bf16 v78, v62, v38
    v_dot2c_f32_bf16 v79, v63, v38
    v_dot2c_f32_bf16 v80, v64, v38
    v_dot2c_f32_bf16 v81, v65, v38
    v_dot2c_f32_bf16 v82, v66, v38
    v_dot2c_f32_bf16 v83, v67, v38
    v_dot2c_f32_bf16 v76, v68, v39
    v_dot2c_f32_bf16 v77, v69, v39
    v_dot2c_f32_bf16 v78, v70, v39
    v_dot2c_f32_bf16 v79, v71, v39
    v_dot2c_f32_bf16 v80, v72, v39
    v_dot2c_f32_bf16 v81, v73, v39
    v_dot2c_f32_bf16 v82, v74, v39
    v_dot2c_f32_bf16 v83, v75, v39
    s_nop 2
    v_permlane32_swap_b32 v76, v80
    v_permlane32_swap_b32 v77, v81
    v_permlane32_swap_b32 v78, v82
    v_permlane32_swap_b32 v79, v83
    v_pk_add_f32 v[12:13], v[76:77], v[80:81]
    v_pk_add_f32 v[14:15], v[78:79], v[82:83]
    v_pk_add_f32 v[16:17], v[76:77], v[80:81]
    v_pk_add_f32 v[18:19], v[78:79], v[82:83]
    s_nop 0
    v_permlane16_swap_b32 v12, v16
    v_permlane16_swap_b32 v13, v17
    v_permlane16_swap_b32 v14, v18
    v_permlane16_swap_b32 v15, v19
    v_pk_add_f32 v[12:13], v[12:13], v[16:17]
    v_pk_add_f32 v[14:15], v[14:15], v[18:19]
    s_nop 0
    v_add_f32_dpp v12, v12, v12 row_ror:8 row_mask:0xf bank_mask:0xf
    v_add_f32_dpp v13, v13, v13 row_ror:8 row_mask:0xf bank_mask:0xf
    v_add_f32_dpp v14, v14, v14 row_ror:8 row_mask:0xf bank_mask:0xf
    v_add_f32_dpp v15, v15, v15 row_ror:8 row_mask:0xf bank_mask:0xf
    s_cmp_eq_u32 s50, 3
    s_cbranch_scc1 L_hb_plain
    v_bfi_b32 v12, s61, v84, v12
    v_bfi_b32 v13, s61, v85, v13
    v_bfi_b32 v14, s61, v86, v14
    v_bfi_b32 v15, s61, v87, v15
    s_branch L_hb_pub
L_hb_plain:
    v_min_u32 v12, -2, v12
    v_min_u32 v13, -2, v13
    v_min_u32 v14, -2, v14
    v_min_u32 v15, -2, v15
L_hb_pub:
    s_mov_b32 exec_lo, 0xff
    s_mov_b32 exec_hi, 0xff
    buffer_store_dwordx4 v[12:15], v92, s[44:47], s54 offen sc1
    s_mov_b64 exec, -1
    s_cmp_eq_u32 s50, 3
    s_cbranch_scc1 L_hb_done
    s_sub_u32 s54, s54, 65536
    v_mov_b32 v76, 0
    v_mov_b32 v77, 0
    v_mov_b32 v78, 0
    v_mov_b32 v79, 0
    v_mov_b32 v80, 0
    v_mov_b32 v81, 0
    v_mov_b32 v82, 0
    v_mov_b32 v83, 0
    v_perm_b32 v44, v196, v192, s48
    v_perm_b32 v45, v196, v192, s49
    v_perm_b32 v46, v197, v193, s48
    v_perm_b32 v47, v197, v193, s49
    v_perm_b32 v48, v198, v194, s48
    v_perm_b32 v49, v198, v194, s49
    v_perm_b32 v50, v199, v195, s48
    v_perm_b32 v51, v199, v195, s49
    v_perm_b32 v52, v204, v200, s48
    v_perm_b32 v53, v204, v200, s49
    v_perm_b32 v54, v205, v201, s48
    v_perm_b32 v55, v205, v201, s49
    v_perm_b32 v56, v206, v202, s48
    v_perm_b32 v57, v206, v202, s49
    v_perm_b32 v58, v207, v203, s48
    v_perm_b32 v59, v207, v203, s49
    v_perm_b32 v60, v212, v208, s48
    v_perm_b32 v61, v212, v208, s49
    v_perm_b32 v62, v213, v209, s48
    v_perm_b32 v63, v213, v209, s49
    v_perm_b32 v64, v214, v210, s48
    v_perm_b32 v65, v214, v210, s49
    v_perm_b32 v66, v215, v211, s48
    v_perm_b32 v67, v215, v211, s49
    v_perm_b32 v68, v220, v216, s48
    v_perm_b32 v69, v220, v216, s49
    v_perm_b32 v70, v221, v217, s48
    v_perm_b32 v71, v221, v217, s49
    v_perm_b32 v72, v222, v218, s48
    v_perm_b32 v73, v222, v218, s49
    v_perm_b32 v74, v223, v219, s48
    v_perm_b32 v75, v223, v219, s49
    s_mov_b32 s62, 4000000
    v_mov_b32 v8, 0
L_wl_84:
    ds_read_b64 v[4:5], v8 offset:8
    s_waitcnt lgkmcnt(0)
    v_min_u32 v4, v4, v5
    s_nop 0
    v_readfirstlane_b32 s63, v4
    s_cmp_ge_u32 s63, 41
    s_cbranch_scc1 L_wlok_85
    s_sleep 8
    s_sub_u32 s62, s62, 1
    s_cmp_lg_u32 s62, 0
    s_cbranch_scc1 L_wl_84
    s_endpgm
L_wlok_85:
    s_mov_b32 s50, 0
    s_mov_b32 s51, 0
    s_branch L_hb_gather
L_hb_keep:
    s_cmp_lg_u32 s50, 0
    s_cbranch_scc1 L_hb_k1
    v_and_b32 v192, 0xffff, v36
    v_lshlrev_b32 v193, 16, v36
    v_lshrrev_b32 v194, 16, v36
    v_and_b32 v195, 0xffff0000, v36
    v_and_b32 v196, 0xffff, v37
    v_lshlrev_b32 v197, 16, v37
    v_lshrrev_b32 v198, 16, v37
    v_and_b32 v199, 0xffff0000, v37
    v_and_b32 v200, 0xffff, v38
    v_lshlrev_b32 v201, 16, v38
    v_lshrrev_b32 v202, 16, v38
    v_and_b32 v203, 0xffff0000, v38
    v_and_b32 v204, 0xffff, v39
    v_lshlrev_b32 v205, 16, v39
    v_lshrrev_b32 v206, 16, v39
    v_and_b32 v207, 0xffff0000, v39
    s_mov_b32 s62, 4000000
    v_mov_b32 v8, 0
L_wl_86:
    ds_read_b64 v[4:5], v8 offset:8
    s_waitcnt lgkmcnt(0)
    v_min_u32 v4, v4, v5
    s_nop 0
    v_readfirstlane_b32 s63, v4
    s_cmp_ge_u32 s63, 49
    s_cbranch_scc1 L_wlok_87
    s_sleep 8
    s_sub_u32 s62, s62, 1
    s_cmp_lg_u32 s62, 0
    s_cbranch_scc1 L_wl_86
    s_endpgm
L_wlok_87:
    s_mov_b32 s50, 1
    s_mov_b32 s51, 1
    s_branch L_hb_gather
L_hb_k1:
    s_cmp_lg_u32 s50, 1
    s_cbranch_scc1 L_hb_k2
    v_and_b32 v208, 0xffff, v36
    v_lshlrev_b32 v209, 16, v36
    v_lshrrev_b32 v210, 16, v36
    v_and_b32 v211, 0xffff0000, v36
    v_and_b32 v212, 0xffff, v37
    v_lshlrev_b32 v213, 16, v37
    v_lshrrev_b32 v214, 16, v37
    v_and_b32 v215, 0xffff0000, v37
    v_and_b32 v216, 0xffff, v38
    v_lshlrev_b32 v217, 16, v38
    v_lshrrev_b32 v218, 16, v38
    v_and_b32 v219, 0xffff0000, v38
    v_and_b32 v220, 0xffff, v39
    v_lshlrev_b32 v221, 16, v39
    v_lshrrev_b32 v222, 16, v39
    v_and_b32 v223, 0xffff0000, v39
    s_cmp_ge_u32 s5, 24
    s_cbranch_scc1 L_hb_shared
    s_add_u32 s51, s40, 50
    s_mov_b32 s62, 4000000
    v_mov_b32 v8, 0
L_wl_88:
    ds_read_b64 v[4:5], v8 offset:8
    s_waitcnt lgkmcnt(0)
    v_min_u32 v4, v4, v5
    s_nop 0
    v_readfirstlane_b32 s63, v4
    s_cmp_ge_u32 s63, s51
    s_cbranch_scc1 L_wlok_89
    s_sleep 8
    s_sub_u32 s62, s62, 1
    s_cmp_lg_u32 s62, 0
    s_cbranch_scc1 L_wl_88
    s_endpgm
L_wlok_89:
    s_mov_b32 s50, 4
    s_add_u32 s51, s40, 2
    s_branch L_hb_gather
L_hb_k2:
    s_cmp_lg_u32 s50, 2
    s_cbranch_scc1 L_hb_k4
    v_and_b32 v224, 0xffff, v36
    v_lshlrev_b32 v225, 16, v36
    v_lshrrev_b32 v226, 16, v36
    v_and_b32 v227, 0xffff0000, v36
    v_and_b32 v228, 0xffff, v37
    v_lshlrev_b32 v229, 16, v37
    v_lshrrev_b32 v230, 16, v37
    v_and_b32 v231, 0xffff0000, v37
    v_and_b32 v232, 0xffff, v38
    v_lshlrev_b32 v233, 16, v38
    v_lshrrev_b32 v234, 16, v38
    v_and_b32 v235, 0xffff0000, v38
    v_and_b32 v236, 0xffff, v39
    v_lshlrev_b32 v237, 16, v39
    v_lshrrev_b32 v238, 16, v39
    v_and_b32 v239, 0xffff0000, v39
    s_mov_b32 s50, 3
    s_add_u32 s52, s55, 245760
    s_branch L_hb_last
L_hb_k4:
    v_and_b32 v4, 1, v2
    v_cmp_eq_u32 vcc, 1, v4
    v_and_b32 v4, 1, v1
    v_lshl_add_u32 v4, v2, 3, v4
    v_lshlrev_b32 v4, 2, v4
    v_cndmask_b32 v12, v12, v16, vcc
    v_cndmask_b32 v13, v13, v17, vcc
    v_cndmask_b32 v14, v14, v18, vcc
    v_cndmask_b32 v15, v15, v19, vcc
    ds_bpermute_b32 v20, v4, v12
    ds_bpermute_b32 v21, v4, v13
    ds_bpermute_b32 v22, v4, v14
    ds_bpermute_b32 v23, v4, v15
    v_lshlrev_b32 v5, 4, v0
    s_lshl_b32 s6, s5, 11
    s_lshl_b32 s7, s4, 8
    s_add_u32 s6, s6, s7
    s_add_u32 s6, s6, 462848
    s_waitcnt lgkmcnt(0)
    v_bfi_b32 v20, s61, v84, v20
    v_bfi_b32 v21, s61, v85, v21
    v_bfi_b32 v22, s61, v86, v22
    v_bfi_b32 v23, s61, v87, v23
    s_mov_b64 exec, 0xffff
    buffer_store_dwordx4 v[20:23], v5, s[44:47], s6 offen sc1
    s_mov_b64 exec, -1
L_hb_shared:
    s_mov_b32 s62, 4000000
    v_mov_b32 v8, 0
L_wl_90:
    ds_read_b64 v[4:5], v8 offset:8
    s_waitcnt lgkmcnt(0)
    v_min_u32 v4, v4, v5
    s_nop 0
    v_readfirstlane_b32 s63, v4
    s_cmp_ge_u32 s63, 61
    s_cbranch_scc1 L_wlok_91
    s_sleep 8
    s_sub_u32 s62, s62, 1
    s_cmp_lg_u32 s62, 0
    s_cbranch_scc1 L_wl_90
    s_endpgm
L_wlok_91:
    s_mov_b32 s50, 2
    s_mul_i32 s52, s4, 3
    s_add_u32 s52, s52, s41
    s_lshl_b32 s52, s52, 11
    s_add_u32 s52, s52, 462848
    s_mov_b32 s62, 400000
    s_mov_b32 s84, -1
    s_mov_b32 s85, 0xffffffff
L_ge_92:
    s_mov_b64 exec, s[84:85]
    s_cbranch_execz L_gs_95
    buffer_load_dwordx4 v[12:15], v93, s[44:47], s52 offen offset:0 sc1
    buffer_load_dwordx4 v[16:19], v94, s[44:47], s52 offen offset:0 sc1
L_gs_95:
L_gemid_94:
    s_mov_b64 vcc, 0
    s_waitcnt vmcnt(0)
    s_mov_b64 exec, s[84:85]
    s_cbranch_execz L_gs_96
    v_xor_b32 v12, v12, v84
    v_xor_b32 v13, v13, v85
    v_xor_b32 v14, v14, v86
    v_xor_b32 v15, v15, v87
    v_xor_b32 v16, v16, v84
    v_xor_b32 v17, v17, v85
    v_xor_b32 v18, v18, v86
    v_xor_b32 v19, v19, v87
    v_or_b32 v4, v12, v13
    v_or3_b32 v4, v4, v14, v15
    v_or3_b32 v4, v4, v16, v17
    v_or3_b32 v4, v4, v18, v19
    v_and_b32 v4, s61, v4
    v_cmp_ne_u32 s[84:85], 0, v4
    s_nop 0
    s_or_b64 vcc, vcc, s[84:85]
L_gs_96:
    s_mov_b64 exec, -1
    s_cmp_eq_u64 vcc, 0
    s_cbranch_scc1 L_geok_93
    s_sleep 16
    s_sub_u32 s62, s62, 1
    s_cmp_lg_u32 s62, 0
    s_cbranch_scc1 L_ge_92
    s_endpgm
L_geok_93:
    s_branch L_hb_summed
L_hb_done:
    s_endpgm
L_finisher:
    s_mov_b32 s56, s4
    s_cmp_eq_u32 s5, 30
    s_cbranch_scc1 L_fin_entry
    s_cmp_lg_u32 s4, 7
    s_cbranch_scc1 L_norank
    v_mul_u32_u24 v4, 4352, v0
    v_mov_b32 v5, 0
    s_mov_b32 s6, 589824
    buffer_store_dword v5, v4, s[44:47], s6 offen sc1
L_norank:
    s_mov_b32 s57, 0
    s_mov_b32 s58, 2
    s_mul_i32 s55, s4, 4352
    s_add_u32 s55, s55, 524540
L_ct_97:
    s_mov_b32 s62, 4000000
    v_mov_b32 v8, 0
L_wl_98:
    ds_read_b64 v[4:5], v8 offset:8
    s_waitcnt lgkmcnt(0)
    v_min_u32 v4, v4, v5
    s_nop 0
    v_readfirstlane_b32 s63, v4
    s_cmp_ge_u32 s63, s58
    s_cbranch_scc1 L_wlok_99
    s_sleep 1
    s_sub_u32 s62, s62, 1
    s_cmp_lg_u32 s62, 0
    s_cbranch_scc1 L_wl_98
    s_endpgm
L_wlok_99:
    s_mul_i32 s59, s58, 4352
    s_add_u32 s59, s59, 589824
    s_mov_b32 s6, 1
    s_atomic_add s6, s[38:39], s59 glc
    s_waitcnt lgkmcnt(0)
    s_min_u32 s6, s6, 7
    s_lshl_b32 s6, s6, 1
    s_sub_u32 s6, s6, 7
    s_mul_i32 s7, s6, 0
    s_add_u32 s57, s57, s7
    s_min_i32 s57, s57, 60
    s_max_i32 s57, s57, -60
    s_cmp_lt_u32 s58, 44
    s_cselect_b32 s7, 2, 4
    s_mul_i32 s6, s6, s7
    s_add_u32 s6, s6, s57
    s_add_u32 s7, s60, 0x1080
    s_add_u32 s6, s6, s7
    v_mov_b32 v4, s6
    s_mov_b64 exec, 1
    buffer_store_dword v4, v8, s[44:47], s55 offen
    s_mov_b64 exec, -1
    s_add_u32 s58, s58, 2
    s_cmp_lt_u32 s58, 62
    s_cbranch_scc1 L_ct_97
    s_endpgm
L_fin_entry:
    s_movk_i32 s61, 0xff
    v_bfe_u32 v84, s60, 0, 8
    v_bfe_u32 v85, s60, 8, 8
    v_bfe_u32 v86, s60, 16, 8
    v_bfe_u32 v87, s60, 24, 8
    v_lshlrev_b32 v3, 4, v2
    v_lshl_add_u32 v93, v1, 8, v3
    v_lshrrev_b32 v4, 4, v0
    v_lshl_add_u32 v3, v4, 1, v3
    s_lshr_b32 s6, s56, 1
    s_and_b32 s7, s56, 1
    s_lshl_b32 s57, s6, 7
    s_mul_i32 s52, s6, 6144
    s_lshl_b32 s6, s7, 3
    s_add_u32 s57, s57, s6
    s_lshl_b32 s6, s7, 7
    s_add_u32 s52, s52, s6
    s_add_u32 s52, s52, 393216
    s_add_u32 s53, s52, 4096
    buffer_load_ushort v64, v3, s[8:11], s57 offen
    s_mov_b32 s12, s34
    s_mov_b32 s13, s35
    s_mov_b32 s14, 1280
    s_mov_b32 s15, 0x20000
    s_mov_b32 s62, 4000000
    v_mov_b32 v8, 0
L_wl_100:
    ds_read_b64 v[4:5], v8 offset:8
    s_waitcnt lgkmcnt(0)
    v_min_u32 v4, v4, v5
    s_nop 0
    v_readfirstlane_b32 s63, v4
    s_cmp_ge_u32 s63, 16
    s_cbranch_scc1 L_wlok_101
    s_sleep 8
    s_sub_u32 s62, s62, 1
    s_cmp_lg_u32 s62, 0
    s_cbranch_scc1 L_wl_100
    s_endpgm
L_wlok_101:
    s_mov_b32 s62, 400000
    s_mov_b32 s84, -1
    s_mov_b32 s85, 0xffffffff
L_ge_102:
    s_mov_b64 exec, s[84:85]
    s_cbranch_execz L_gs_105
    buffer_load_dwordx4 v[96:99], v93, s[44:47], s52 offen offset:0 sc1
    buffer_load_dwordx4 v[100:103], v93, s[44:47], s52 offen offset:2048 sc1
    buffer_load_dwordx4 v[104:107], v93, s[44:47], s53 offen offset:0 sc1
L_gs_105:
L_gemid_104:
    s_mov_b64 vcc, 0
    s_waitcnt vmcnt(0)
    s_mov_b64 exec, s[84:85]
    s_cbranch_execz L_gs_106
    v_xor_b32 v96, v96, v84
    v_xor_b32 v97, v97, v85
    v_xor_b32 v98, v98, v86
    v_xor_b32 v99, v99, v87
    v_xor_b32 v100, v100, v84
    v_xor_b32 v101, v101, v85
    v_xor_b32 v102, v102, v86
    v_xor_b32 v103, v103, v87
    v_xor_b32 v104, v104, v84
    v_xor_b32 v105, v105, v85
    v_xor_b32 v106, v106, v86
    v_xor_b32 v107, v107, v87
    v_or_b32 v4, v96, v97
    v_or3_b32 v4, v4, v98, v99
    v_or3_b32 v4, v4, v100, v101
    v_or3_b32 v4, v4, v102, v103
    v_or3_b32 v4, v4, v104, v105
    v_or3_b32 v4, v4, v106, v107
    v_and_b32 v4, s61, v4
    v_cmp_ne_u32 s[84:85], 0, v4
    s_nop 0
    s_or_b64 vcc, vcc, s[84:85]
    s_cmp_lg_u64 s[84:85], 0
    s_cselect_b64 s[84:85], -1, 0
L_gs_106:
    s_mov_b64 exec, -1
    s_cmp_eq_u64 vcc, 0
    s_cbranch_scc1 L_geok_103
    s_sleep 32
    s_sub_u32 s62, s62, 1
    s_cmp_lg_u32 s62, 0
    s_cbranch_scc1 L_ge_102
    s_endpgm
L_geok_103:
    v_pk_add_f32 v[12:13], v[96:97], v[100:101]
    v_pk_add_f32 v[14:15], v[98:99], v[102:103]
    v_pk_add_f32 v[12:13], v[12:13], v[104:105]
    v_pk_add_f32 v[14:15], v[14:15], v[106:107]
    s_nop 1
    v_permlane32_swap_b32 v12, v14
    v_permlane32_swap_b32 v13, v15
    s_nop 0
    v_pk_add_f32 v[12:13], v[12:13], v[14:15]
    s_nop 1
    v_permlane16_swap_b32 v12, v13
    s_nop 0
    v_add_f32 v12, v12, v13
    s_nop 1
    v_add_f32_dpp v12, v12, v12 row_ror:8 row_mask:0xf bank_mask:0xf
    v_cvt_pk_bf16_f32 v12, v12, v12
    v_and_b32 v12, 0xffff0000, v12
    v_mov_b32 v65, v12
    v_lshlrev_b32 v64, 16, v64
    s_sub_u32 s52, s52, 65536
    s_add_u32 s53, s52, 4096
    s_mov_b32 s62, 4000000
    v_mov_b32 v8, 0
L_wl_107:
    ds_read_b64 v[4:5], v8 offset:8
    s_waitcnt lgkmcnt(0)
    v_min_u32 v4, v4, v5
    s_nop 0
    v_readfirstlane_b32 s63, v4
    s_cmp_ge_u32 s63, 60
    s_cbranch_scc1 L_wlok_108
    s_sleep 8
    s_sub_u32 s62, s62, 1
    s_cmp_lg_u32 s62, 0
    s_cbranch_scc1 L_wl_107
    s_endpgm
L_wlok_108:
    s_mov_b32 s62, 4000000
    v_mov_b32 v8, 0
L_wl_109:
    ds_read_b64 v[4:5], v8 offset:8
    s_waitcnt lgkmcnt(0)
    v_min_u32 v4, v4, v5
    s_nop 0
    v_readfirstlane_b32 s63, v4
    s_cmp_ge_u32 s63, 65
    s_cbranch_scc1 L_wlok_110
    s_sleep 1
    s_sub_u32 s62, s62, 1
    s_cmp_lg_u32 s62, 0
    s_cbranch_scc1 L_wl_109
    s_endpgm
L_wlok_110:
    s_mov_b32 s62, 400000
    buffer_load_dwordx4 v[96:99], v93, s[44:47], s52 offen offset:0 sc1
    buffer_load_dwordx4 v[100:103], v93, s[44:47], s52 offen offset:2048 sc1
    buffer_load_dwordx4 v[104:107], v93, s[44:47], s53 offen offset:0 sc1
    buffer_load_dwordx4 v[108:111], v93, s[44:47], s52 offen offset:0 sc1
    buffer_load_dwordx4 v[112:115], v93, s[44:47], s52 offen offset:2048 sc1
    buffer_load_dwordx4 v[116:119], v93, s[44:47], s53 offen offset:0 sc1
    buffer_load_dwordx4 v[120:123], v93, s[44:47], s52 offen offset:0 sc1
    buffer_load_dwordx4 v[124:127], v93, s[44:47], s52 offen offset:2048 sc1
    buffer_load_dwordx4 v[128:131], v93, s[44:47], s53 offen offset:0 sc1
L_fin_poll:
    s_waitcnt vmcnt(6)
    v_max_u32 v4, v96, v97
    v_max3_u32 v4, v4, v98, v99
    v_max3_u32 v4, v4, v100, v101
    v_max3_u32 v4, v4, v102, v103
    v_max3_u32 v4, v4, v104, v105
    v_max3_u32 v4, v4, v106, v107
    v_cmp_eq_u32 vcc, -1, v4
    v_pk_add_f32 v[12:13], v[96:97], v[100:101]
    v_pk_add_f32 v[14:15], v[98:99], v[102:103]
    v_pk_add_f32 v[12:13], v[12:13], v[104:105]
    v_pk_add_f32 v[14:15], v[14:15], v[106:107]
    s_nop 1
    v_permlane32_swap_b32 v12, v14
    v_permlane32_swap_b32 v13, v15
    s_nop 0
    v_pk_add_f32 v[12:13], v[12:13], v[14:15]
    s_nop 1
    v_permlane16_swap_b32 v12, v13
    s_nop 0
    v_add_f32 v12, v12, v13
    s_nop 1
    v_add_f32_dpp v12, v12, v12 row_ror:8 row_mask:0xf bank_mask:0xf
    v_cvt_pk_bf16_f32 v12, v12, v12
    v_and_b32 v12, 0xffff0000, v12
    v_add_f32 v12, v12, v64
    v_cvt_pk_bf16_f32 v12, v12, v12
    v_and_b32 v12, 0xffff0000, v12
    v_add_f32 v12, v12, v65
    v_cvt_pk_bf16_f32 v12, v12, v12
    s_cbranch_vccz L_fin_got
    buffer_load_dwordx4 v[96:99], v93, s[44:47], s52 offen offset:0 sc1
    buffer_load_dwordx4 v[100:103], v93, s[44:47], s52 offen offset:2048 sc1
    buffer_load_dwordx4 v[104:107], v93, s[44:47], s53 offen offset:0 sc1
    s_waitcnt vmcnt(6)
    v_max_u32 v4, v108, v109
    v_max3_u32 v4, v4, v110, v111
    v_max3_u32 v4, v4, v112, v113
    v_max3_u32 v4, v4, v114, v115
    v_max3_u32 v4, v4, v116, v117
    v_max3_u32 v4, v4, v118, v119
    v_cmp_eq_u32 vcc, -1, v4
    v_pk_add_f32 v[12:13], v[108:109], v[112:113]
    v_pk_add_f32 v[14:15], v[110:111], v[114:115]
    v_pk_add_f32 v[12:13], v[12:13], v[116:117]
    v_pk_add_f32 v[14:15], v[14:15], v[118:119]
    s_nop 1
    v_permlane32_swap_b32 v12, v14
    v_permlane32_swap_b32 v13, v15
    s_nop 0
    v_pk_add_f32 v[12:13], v[12:13], v[14:15]
    s_nop 1
    v_permlane16_swap_b32 v12, v13
    s_nop 0
    v_add_f32 v12, v12, v13
    s_nop 1
    v_add_f32_dpp v12, v12, v12 row_ror:8 row_mask:0xf bank_mask:0xf
    v_cvt_pk_bf16_f32 v12, v12, v12
    v_and_b32 v12, 0xffff0000, v12
    v_add_f32 v12, v12, v64
    v_cvt_pk_bf16_f32 v12, v12, v12
    v_and_b32 v12, 0xffff0000, v12
    v_add_f32 v12, v12, v65
    v_cvt_pk_bf16_f32 v12, v12, v12
    s_cbranch_vccz L_fin_got
    buffer_load_dwordx4 v[108:111], v93, s[44:47], s52 offen offset:0 sc1
    buffer_load_dwordx4 v[112:115], v93, s[44:47], s52 offen offset:2048 sc1
    buffer_load_dwordx4 v[116:119], v93, s[44:47], s53 offen offset:0 sc1
    s_waitcnt vmcnt(6)
    v_max_u32 v4, v120, v121
    v_max3_u32 v4, v4, v122, v123
    v_max3_u32 v4, v4, v124, v125
    v_max3_u32 v4, v4, v126, v127
    v_max3_u32 v4, v4, v128, v129
    v_max3_u32 v4, v4, v130, v131
    v_cmp_eq_u32 vcc, -1, v4
    v_pk_add_f32 v[12:13], v[120:121], v[124:125]
    v_pk_add_f32 v[14:15], v[122:123], v[126:127]
    v_pk_add_f32 v[12:13], v[12:13], v[128:129]
    v_pk_add_f32 v[14:15], v[14:15], v[130:131]
    s_nop 1
    v_permlane32_swap_b32 v12, v14
    v_permlane32_swap_b32 v13, v15
    s_nop 0
    v_pk_add_f32 v[12:13], v[12:13], v[14:15]
    s_nop 1
    v_permlane16_swap_b32 v12, v13
    s_nop 0
    v_add_f32 v12, v12, v13
    s_nop 1
    v_add_f32_dpp v12, v12, v12 row_ror:8 row_mask:0xf bank_mask:0xf
    v_cvt_pk_bf16_f32 v12, v12, v12
    v_and_b32 v12, 0xffff0000, v12
    v_add_f32 v12, v12, v64
    v_cvt_pk_bf16_f32 v12, v12, v12
    v_and_b32 v12, 0xffff0000, v12
    v_add_f32 v12, v12, v65
    v_cvt_pk_bf16_f32 v12, v12, v12
    s_cbranch_vccz L_fin_got
    buffer_load_dwordx4 v[120:123], v93, s[44:47], s52 offen offset:0 sc1
    buffer_load_dwordx4 v[124:127], v93, s[44:47], s52 offen offset:2048 sc1
    buffer_load_dwordx4 v[128:131], v93, s[44:47], s53 offen offset:0 sc1
    s_sub_u32 s62, s62, 1
    s_cmp_lg_u32 s62, 0
    s_cbranch_scc1 L_fin_poll
    s_endpgm
L_fin_got:
    s_mov_b32 exec_lo, 0x00ff00ff
    s_mov_b32 exec_hi, 0x00ff00ff
    buffer_store_short v12, v3, s[12:15], s57 offen
    s_cmp_lg_u32 s56, 0
    s_cbranch_scc1 L_fin_done
    v_mov_b32 v4, s60
    v_mov_b32 v5, 3080192
    s_mov_b64 exec, 1
    buffer_store_dword v4, v5, s[44:47], 0 offen
L_fin_done:
L_exit:
    s_endpgm
L_code_end:
.section .rodata,"a"
.p2align 6
.amdhsa_kernel parallel_sum__mha_block_cached__geglu_ffn__decode_kernel
  .amdhsa_next_free_vgpr 256
  .amdhsa_next_free_sgpr 96
  .amdhsa_accum_offset 256
  .amdhsa_group_segment_fixed_size 0
  .amdhsa_kernarg_size 96
  .amdhsa_user_sgpr_count 2
  .amdhsa_user_sgpr_kernarg_segment_ptr 1
  .amdhsa_system_sgpr_workgroup_id_x 1
.end_amdhsa_kernel
```
